```python
import torch

def _softmax(x, axis=-1):
    return torch.softmax(x, dim=axis)
def _gelu(x):
    return torch.nn.functional.gelu(x, approximate="tanh")
def _silu(x):
    return torch.nn.functional.silu(x)
def _sigmoid(x):
    return torch.sigmoid(x)
def _layernorm(x, axis=-1, eps=1e-5):
    m = x.mean(dim=axis, keepdim=True)
    v = x.var(dim=axis, keepdim=True, unbiased=False)
    return (x - m) / torch.sqrt(v + eps)
def _scatter_add(tgt, idx, src, axis=0):
    return tgt.clone().index_add_(axis, idx, src)
def _segment_sum(src, seg, n):
    out = torch.zeros((n,) + src.shape[1:], dtype=src.dtype)
    return out.index_add_(0, seg, src)
def _pad(x, pw):
    flat = tuple(v for pair in reversed(pw) for v in pair)
    return torch.nn.functional.pad(x, flat)

kernel_name = 'standalone__weight_only_int_omniquant__prompt'

def setup_inputs():

    _w = (lambda a: (lambda t: t.to(torch.bfloat16) if t.is_floating_point() else t)(torch.as_tensor(a)))
    B, S, D, F = 1, 2048, 1024, 3584
    bits = 4
    G = -1 if -1 > 0 else D
    D = (D // G) * G
    ng = D // G
    qmax = (1 << bits) - 1
    qw = torch.randint(0, qmax + 1, (D, F)).to(torch.int32)
    scales = (torch.abs((lambda *s: torch.randn(*s, dtype=torch.bfloat16) * 0.05)(ng, F)) * 0.05 + 0.01).to(float)
    zeros = torch.randint(0, qmax + 1, (ng, F)).to(float)
    act_scale = (torch.abs((lambda *s: torch.randn(*s, dtype=torch.bfloat16) * 0.05)(D)) * 0.5 + 0.5).to(float)
    return {
        "x": _w((lambda *s: torch.randn(*s, dtype=torch.bfloat16) * 0.05)(B, S, D)),
        "qw": _w(qw),
        "scales": _w(scales),
        "zeros": _w(zeros),
        "act_scale": _w(act_scale),
    }

def reference(x, qw, scales, zeros, act_scale):
    B, S, D = x.shape
    ng, F = scales.shape
    G = D // ng
    s = (lambda x, n, axis: torch.repeat_interleave(x, n, dim=axis))(scales, G, axis=0)
    z = (lambda x, n, axis: torch.repeat_interleave(x, n, dim=axis))(zeros, G, axis=0)
    w = ((lambda x, dt: x.to(dt))(qw, x.dtype) - z) * s
    xs = x * (lambda x, dt: x.to(dt))(act_scale, x.dtype)
    return torch.einsum("bsd,df->bsf", xs, w)
```

```asm
; @launch grid=(256,1,1) block=(512,1,1) lds=145408
.amdgcn_target "amdgcn-amd-amdhsa--gfx950"
.text
.globl standalone__weight_only_int_omniquant__prompt_kernel
.p2align 8
.type standalone__weight_only_int_omniquant__prompt_kernel,@function
standalone__weight_only_int_omniquant__prompt_kernel:
s_cmp_ge_u32 s2, 0x100
s_cbranch_scc1 L_end
s_load_dwordx16 s[4:19], s[0:1], 0
v_lshrrev_b32 v1, 6, v0
v_and_b32 v2, 63, v0
v_readfirstlane_b32 s38, v1
s_nop 0
s_cmp_lg_u32 s38, 1
s_cbranch_scc1 L_nopf
s_getpc_b64 s[42:43]
L_pc0:
s_sub_u32 s42, s42, L_pc0-standalone__weight_only_int_omniquant__prompt_kernel
s_subb_u32 s43, s43, 0
v_lshlrev_b32 v3, 7, v2
v_min_u32 v3, L_pfend-standalone__weight_only_int_omniquant__prompt_kernel, v3
v_mov_b32 v5, s43
v_add_co_u32 v4, vcc, s42, v3
s_nop 1
v_addc_co_u32 v5, vcc, 0, v5, vcc
global_load_dword v255, v[4:5], off
v_add_u32 v3, 8192, v3
v_min_u32 v3, L_pfend-standalone__weight_only_int_omniquant__prompt_kernel, v3
v_mov_b32 v5, s43
v_add_co_u32 v4, vcc, s42, v3
s_nop 1
v_addc_co_u32 v5, vcc, 0, v5, vcc
global_load_dword v254, v[4:5], off
L_nopf:
s_and_b32 s39, s2, 7
s_lshr_b32 s40, s2, 3
s_and_b32 s36, s40, 7
s_lshr_b32 s37, s40, 3
s_lshl_b32 s39, s39, 2
s_add_u32 s37, s37, s39
s_cmp_lt_u32 s38, 4
s_cbranch_scc1 L_consumer
s_sub_u32 s38, s38, 4
v_and_b32 v3, 31, v2
v_lshrrev_b32 v4, 5, v2
v_mul_u32_u24 v5, 114688, v4
v_lshl_add_u32 v5, v3, 4, v5
s_mul_i32 s41, s38, 229376
s_mul_i32 s42, s37, 448
s_add_u32 s41, s41, s42
v_add_u32 v5, s41, v5
v_cmp_gt_u32 vcc, 28, v3
v_mov_b32 v6, 0x80000000
s_mul_i32 s47, s36, 917504
v_cndmask_b32 v140, v6, v5, vcc
s_mov_b64 s[52:53], vcc
v_add_u32 v141, 14336, v140
v_add_u32 v142, 28672, v140
v_add_u32 v143, 43008, v140
v_add_u32 v144, 57344, v140
v_add_u32 v145, 71680, v140
v_add_u32 v146, 86016, v140
v_add_u32 v147, 100352, v140
s_add_u32 s63, s47, 7340032
s_mov_b32 s26, 14680064
s_mov_b32 s27, 0x20000
s_waitcnt lgkmcnt(0)
s_mov_b32 s24, s6
s_mov_b32 s25, s7
s_mov_b32 s20, s4
s_mov_b32 s21, s5
buffer_load_dwordx4 v[8:11], v140, s[24:27], s47 offen nt
buffer_load_dwordx4 v[12:15], v141, s[24:27], s47 offen nt
buffer_load_dwordx4 v[16:19], v142, s[24:27], s47 offen nt
buffer_load_dwordx4 v[20:23], v143, s[24:27], s47 offen nt
s_mov_b32 s84, s12
s_mov_b32 s85, s13
s_mov_b32 s86, 2048
s_mov_b32 s87, 0x20000
s_mov_b32 s88, s10
s_mov_b32 s89, s11
s_mov_b32 s90, 7168
s_mov_b32 s91, 0x20000
s_mul_i32 s42, s37, 224
v_lshl_add_u32 v7, v3, 3, s42
v_lshrrev_b32 v5, 2, v2
v_and_b32 v6, 3, v2
v_lshlrev_b32 v6, 3, v6
v_lshl_add_u32 v5, v5, 7, v6
s_lshl_b32 s46, s38, 5
v_add_u32 v108, s46, v5
buffer_load_dwordx2 v[110:111], v108, s[84:87], 0 offen
buffer_load_dwordx2 v[112:113], v7, s[88:91], 0 offen
buffer_load_dwordx4 v[24:27], v144, s[24:27], s47 offen nt
buffer_load_dwordx4 v[28:31], v145, s[24:27], s47 offen nt
buffer_load_dwordx4 v[32:35], v146, s[24:27], s47 offen nt
buffer_load_dwordx4 v[36:39], v147, s[24:27], s47 offen nt
v_lshrrev_b32 v5, 3, v2
v_and_b32 v6, 7, v2
v_xor_b32 v6, v6, v5
v_lshlrev_b32 v6, 4, v6
v_lshl_add_u32 v100, v5, 11, v6
s_lshl_b32 s45, s36, 19
s_lshl_b32 s46, s38, 17
s_add_u32 s45, s45, s46
v_add_u32 v132, s45, v100
v_add_u32 v133, 15360, v132
v_add_u32 v134, 30720, v132
v_add_u32 v135, 46080, v132
v_add_u32 v136, 65536, v132
v_add_u32 v137, 80896, v132
v_add_u32 v138, 96256, v132
v_add_u32 v139, 111616, v132
s_lshl_b32 s44, s38, 13
s_lshl_b32 s41, s36, 7
s_add_u32 s43, s41, 1024
s_add_u32 s45, s36, 1
s_and_b32 s45, s45, 7
s_lshl_b32 s82, s45, 7
s_mov_b32 s22, 4194304
s_mov_b32 s23, 0x20000
s_mov_b32 s28, s18
s_mov_b32 s29, s19
s_mov_b32 s30, 7372800
s_mov_b32 s31, 0x20000
s_mov_b32 s92, s16
s_mov_b32 s93, s17
s_mov_b32 s94, 256
s_mov_b32 s95, 0x20000
s_lshl_b32 s51, s37, 4
s_mul_i32 s46, s38, 3584
s_add_u32 s50, s46, 98304
v_lshl_add_u32 v168, v2, 4, s46
v_lshl_add_u32 v5, v2, 7, s46
v_cmp_gt_u32 vcc, 28, v2
v_mov_b32 v6, 0x80000000
s_nop 0
v_cndmask_b32 v179, v6, v5, vcc
s_add_u32 s45, s36, s51
s_mul_i32 s48, s45, 14336
s_add_u32 s83, s48, 114688
s_lshl_b32 s45, s38, 1
v_add_u32 v4, s45, v4
v_mul_u32_u24 v4, 1792, v4
s_and_b32 s45, s37, 3
s_lshl_b32 s54, s45, 5
s_add_u32 s55, s54, 128
s_sub_u32 s56, s54, 64
s_cmp_ge_u32 s45, 2
s_cselect_b32 s55, s56, s55
s_bitcmp1_b32 s45, 0
s_cselect_b32 s56, 0, 192
s_lshr_b32 s54, s54, 3
s_lshr_b32 s55, s55, 3
s_lshr_b32 s56, s56, 3
v_subrev_u32 v118, s54, v3
v_subrev_u32 v5, s55, v3
v_subrev_u32 v6, s56, v3
v_cmp_gt_u32 s[54:55], 16, v118
v_cmp_gt_u32 s[56:57], 8, v5
v_add_u32 v5, 64, v5
v_add_u32 v6, 96, v6
v_add_u32 v114, 0, v6
v_add_u32 v115, 0, v5
v_add_u32 v116, 0, v118
v_cndmask_b32 v114, v114, v115, s[56:57]
v_cndmask_b32 v114, v114, v116, s[54:55]
v_lshl_add_u32 v164, v114, 4, v4
v_add_u32 v102, 98304, v164
v_add_u32 v114, 4, v6
v_add_u32 v115, 16, v5
v_add_u32 v116, 16, v118
v_cndmask_b32 v114, v114, v115, s[56:57]
v_cndmask_b32 v114, v114, v116, s[54:55]
v_lshl_add_u32 v165, v114, 4, v4
v_add_u32 v103, 98304, v165
v_add_u32 v114, 8, v6
v_add_u32 v115, 8, v5
v_add_u32 v116, 32, v118
v_cndmask_b32 v114, v114, v115, s[56:57]
v_cndmask_b32 v114, v114, v116, s[54:55]
v_lshl_add_u32 v166, v114, 4, v4
v_add_u32 v104, 98304, v166
v_add_u32 v114, 12, v6
v_add_u32 v115, 24, v5
v_add_u32 v116, 48, v118
v_cndmask_b32 v114, v114, v115, s[56:57]
v_cndmask_b32 v114, v114, v116, s[54:55]
v_lshl_add_u32 v167, v114, 4, v4
v_add_u32 v105, 98304, v167
s_lshl_b32 s45, s37, 2
s_add_u32 s45, s45, s38
s_lshl_b32 s45, s45, 8
s_add_u32 s45, s45, 7340032
v_and_b32 v5, 7, v2
v_lshl_add_u32 v172, v5, 3, s45
s_lshl_b32 s46, s36, 3
s_add_u32 s45, s45, s46
v_mov_b32 v177, s45
s_lshl_b32 s45, s37, 3
v_mov_b32 v178, s45
s_getreg_b32 s59, hwreg(HW_REG_XCC_ID, 0, 4)
s_lshl_b32 s59, s59, 28
s_mov_b32 s57, 0
s_mov_b32 s39, 0
v_lshrrev_b32 v5, 1, v2
v_and_b32 v117, 15, v5
v_cmp_gt_u32 vcc, 9, v117
v_add_u32 v6, s36, v117
v_subrev_u32 v116, 1, v6
v_cndmask_b32 v6, v6, v116, vcc
v_and_b32 v6, 7, v6
v_cmp_le_u32 vcc, 9, v117
v_mov_b32 v116, 8
v_or_b32 v116, v116, v6
v_cndmask_b32 v6, v6, v116, vcc
v_cmp_eq_u32 vcc, 0, v117
v_mov_b32 v116, s36
s_nop 0
v_cndmask_b32 v6, v6, v116, vcc
v_cmp_eq_u32 vcc, 1, v117
v_add_u32 v116, 8, v116
s_nop 0
v_cndmask_b32 v6, v6, v116, vcc
v_lshlrev_b32 v6, 7, v6
v_and_b32 v114, 1, v2
v_lshl_add_u32 v6, v114, 11, v6
s_lshl_b32 s45, s36, 8
s_lshl_b32 s46, s37, 3
s_add_u32 s45, s45, s46
s_lshl_b32 s46, s38, 1
s_add_u32 s45, s45, s46
s_lshl_b32 s45, s45, 11
v_add_u32 v6, s45, v6
v_cmp_gt_u32 vcc, 7, v5
v_mov_b32 v114, 0x80000000
s_nop 0
v_cndmask_b32 v180, v114, v6, vcc
v_subrev_u32 v5, 7, v5
v_cmp_gt_u32 vcc, 9, v5
s_nop 1
v_cndmask_b32 v176, v114, v6, vcc
s_lshl_b32 s45, s38, 10
s_add_u32 s45, s45, 141312
v_lshl_add_u32 v107, v2, 4, s45
v_lshrrev_b32 v5, 5, v2
v_lshl_add_u32 v106, v5, 5, s45
s_lshl_b32 s45, s36, 6
v_add_u32 v109, s45, v106
buffer_load_dword v120, v180, s[20:23], 0 offen
buffer_load_dwordx4 v[40:43], v140, s[24:27], s63 offen nt
s_add_u32 m0, s44, 0
s_nop 0
buffer_load_dwordx4 v132, s[20:23], s41 offen offset:0  lds
buffer_load_dwordx4 v[44:47], v141, s[24:27], s63 offen nt
buffer_load_dwordx4 v133, s[20:23], s41 offen offset:1024  lds
buffer_load_dwordx4 v[48:51], v142, s[24:27], s63 offen nt
buffer_load_dwordx4 v134, s[20:23], s41 offen offset:2048  lds
buffer_load_dwordx4 v[52:55], v143, s[24:27], s63 offen nt
buffer_load_dwordx4 v135, s[20:23], s41 offen offset:3072  lds
buffer_load_dwordx4 v[56:59], v144, s[24:27], s63 offen nt
s_add_u32 m0, s44, 4096
s_nop 0
buffer_load_dwordx4 v136, s[20:23], s41 offen offset:0  lds
buffer_load_dwordx4 v[60:63], v145, s[24:27], s63 offen nt
buffer_load_dwordx4 v137, s[20:23], s41 offen offset:1024  lds
buffer_load_dwordx4 v[64:67], v146, s[24:27], s63 offen nt
buffer_load_dwordx4 v138, s[20:23], s41 offen offset:2048  lds
buffer_load_dwordx4 v[68:71], v147, s[24:27], s63 offen nt
buffer_load_dwordx4 v139, s[20:23], s41 offen offset:3072  lds
buffer_load_dwordx2 v[170:171], v178, s[92:95], 0 offen sc1
buffer_load_dword v121, v172, s[28:31], 0 offen sc1
s_waitcnt vmcnt(23)
v_lshlrev_b32 v114, 16, v110
v_and_b32 v115, 0xffff0000, v110
v_lshlrev_b32 v116, 16, v111
v_and_b32 v117, 0xffff0000, v111
ds_write_b128 v107, v[114:117]
v_lshlrev_b32 v96, 16, v112
v_and_b32 v97, 0xffff0000, v112
v_lshlrev_b32 v98, 16, v113
v_and_b32 v99, 0xffff0000, v113
ds_read_b128 v[88:91], v109
ds_read_b128 v[92:95], v109 offset:16
ds_read_b128 v[124:127], v109 offset:512
ds_read_b128 v[128:131], v109 offset:528
s_waitcnt lgkmcnt(0)
v_cvt_f32_i32 v8, v8
v_cvt_f32_i32 v9, v9
v_cvt_f32_i32 v10, v10
v_cvt_f32_i32 v11, v11
v_sub_f32 v8, v8, v96
v_sub_f32 v9, v9, v97
v_sub_f32 v10, v10, v98
v_sub_f32 v11, v11, v99
v_mul_f32 v8, v8, v88
v_mul_f32 v9, v9, v88
v_mul_f32 v10, v10, v88
v_mul_f32 v11, v11, v88
v_cvt_f32_i32 v12, v12
v_cvt_f32_i32 v13, v13
v_cvt_f32_i32 v14, v14
v_cvt_f32_i32 v15, v15
v_sub_f32 v12, v12, v96
v_sub_f32 v13, v13, v97
v_sub_f32 v14, v14, v98
v_sub_f32 v15, v15, v99
v_mul_f32 v12, v12, v89
v_mul_f32 v13, v13, v89
v_mul_f32 v14, v14, v89
v_mul_f32 v15, v15, v89
v_cvt_pk_bf16_f32 v72, v8, v12
v_cvt_pk_bf16_f32 v76, v9, v13
v_cvt_pk_bf16_f32 v80, v10, v14
v_cvt_pk_bf16_f32 v84, v11, v15
v_cvt_f32_i32 v16, v16
v_cvt_f32_i32 v17, v17
v_cvt_f32_i32 v18, v18
v_cvt_f32_i32 v19, v19
v_sub_f32 v16, v16, v96
v_sub_f32 v17, v17, v97
v_sub_f32 v18, v18, v98
v_sub_f32 v19, v19, v99
v_mul_f32 v16, v16, v90
v_mul_f32 v17, v17, v90
v_mul_f32 v18, v18, v90
v_mul_f32 v19, v19, v90
v_cvt_f32_i32 v20, v20
v_cvt_f32_i32 v21, v21
v_cvt_f32_i32 v22, v22
v_cvt_f32_i32 v23, v23
v_sub_f32 v20, v20, v96
v_sub_f32 v21, v21, v97
v_sub_f32 v22, v22, v98
v_sub_f32 v23, v23, v99
v_mul_f32 v20, v20, v91
v_mul_f32 v21, v21, v91
v_mul_f32 v22, v22, v91
v_mul_f32 v23, v23, v91
v_cvt_pk_bf16_f32 v73, v16, v20
v_cvt_pk_bf16_f32 v77, v17, v21
v_cvt_pk_bf16_f32 v81, v18, v22
v_cvt_pk_bf16_f32 v85, v19, v23
s_waitcnt vmcnt(22)
v_cvt_f32_i32 v24, v24
v_cvt_f32_i32 v25, v25
v_cvt_f32_i32 v26, v26
v_cvt_f32_i32 v27, v27
v_sub_f32 v24, v24, v96
v_sub_f32 v25, v25, v97
v_sub_f32 v26, v26, v98
v_sub_f32 v27, v27, v99
v_mul_f32 v24, v24, v92
v_mul_f32 v25, v25, v92
v_mul_f32 v26, v26, v92
v_mul_f32 v27, v27, v92
s_waitcnt vmcnt(21)
v_cvt_f32_i32 v28, v28
v_cvt_f32_i32 v29, v29
v_cvt_f32_i32 v30, v30
v_cvt_f32_i32 v31, v31
v_sub_f32 v28, v28, v96
v_sub_f32 v29, v29, v97
v_sub_f32 v30, v30, v98
v_sub_f32 v31, v31, v99
v_mul_f32 v28, v28, v93
v_mul_f32 v29, v29, v93
v_mul_f32 v30, v30, v93
v_mul_f32 v31, v31, v93
v_cvt_pk_bf16_f32 v74, v24, v28
v_cvt_pk_bf16_f32 v78, v25, v29
v_cvt_pk_bf16_f32 v82, v26, v30
v_cvt_pk_bf16_f32 v86, v27, v31
s_waitcnt vmcnt(20)
v_cvt_f32_i32 v32, v32
v_cvt_f32_i32 v33, v33
v_cvt_f32_i32 v34, v34
v_cvt_f32_i32 v35, v35
v_sub_f32 v32, v32, v96
v_sub_f32 v33, v33, v97
v_sub_f32 v34, v34, v98
v_sub_f32 v35, v35, v99
v_mul_f32 v32, v32, v94
v_mul_f32 v33, v33, v94
v_mul_f32 v34, v34, v94
v_mul_f32 v35, v35, v94
s_waitcnt vmcnt(19)
v_cvt_f32_i32 v36, v36
v_cvt_f32_i32 v37, v37
v_cvt_f32_i32 v38, v38
v_cvt_f32_i32 v39, v39
v_sub_f32 v36, v36, v96
v_sub_f32 v37, v37, v97
v_sub_f32 v38, v38, v98
v_sub_f32 v39, v39, v99
v_mul_f32 v36, v36, v95
v_mul_f32 v37, v37, v95
v_mul_f32 v38, v38, v95
v_mul_f32 v39, v39, v95
v_cvt_pk_bf16_f32 v75, v32, v36
v_cvt_pk_bf16_f32 v79, v33, v37
v_cvt_pk_bf16_f32 v83, v34, v38
v_cvt_pk_bf16_f32 v87, v35, v39
s_mov_b64 exec, s[52:53]
ds_write_b128 v102, v[72:75] offset:0
ds_write_b128 v103, v[76:79] offset:0
ds_write_b128 v104, v[80:83] offset:0
ds_write_b128 v105, v[84:87] offset:0
s_mov_b64 exec, -1
s_mov_b64 exec, s[52:53]
buffer_store_dwordx4 v[72:75], v164, s[28:31], s48 offen
buffer_store_dwordx4 v[76:79], v165, s[28:31], s48 offen
buffer_store_dwordx4 v[80:83], v166, s[28:31], s48 offen
buffer_store_dwordx4 v[84:87], v167, s[28:31], s48 offen
s_mov_b64 exec, -1
s_waitcnt vmcnt(21)
v_cvt_f32_i32 v40, v40
v_cvt_f32_i32 v41, v41
v_cvt_f32_i32 v42, v42
v_cvt_f32_i32 v43, v43
v_sub_f32 v40, v40, v96
v_sub_f32 v41, v41, v97
v_sub_f32 v42, v42, v98
v_sub_f32 v43, v43, v99
v_mul_f32 v40, v40, v124
v_mul_f32 v41, v41, v124
v_mul_f32 v42, v42, v124
v_mul_f32 v43, v43, v124
s_waitcnt vmcnt(19)
v_cvt_f32_i32 v44, v44
v_cvt_f32_i32 v45, v45
v_cvt_f32_i32 v46, v46
v_cvt_f32_i32 v47, v47
v_sub_f32 v44, v44, v96
v_sub_f32 v45, v45, v97
v_sub_f32 v46, v46, v98
v_sub_f32 v47, v47, v99
v_mul_f32 v44, v44, v125
v_mul_f32 v45, v45, v125
v_mul_f32 v46, v46, v125
v_mul_f32 v47, v47, v125
v_cvt_pk_bf16_f32 v148, v40, v44
v_cvt_pk_bf16_f32 v152, v41, v45
v_cvt_pk_bf16_f32 v156, v42, v46
v_cvt_pk_bf16_f32 v160, v43, v47
s_waitcnt vmcnt(17)
v_cvt_f32_i32 v48, v48
v_cvt_f32_i32 v49, v49
v_cvt_f32_i32 v50, v50
v_cvt_f32_i32 v51, v51
v_sub_f32 v48, v48, v96
v_sub_f32 v49, v49, v97
v_sub_f32 v50, v50, v98
v_sub_f32 v51, v51, v99
v_mul_f32 v48, v48, v126
v_mul_f32 v49, v49, v126
v_mul_f32 v50, v50, v126
v_mul_f32 v51, v51, v126
s_waitcnt vmcnt(15)
v_cvt_f32_i32 v52, v52
v_cvt_f32_i32 v53, v53
v_cvt_f32_i32 v54, v54
v_cvt_f32_i32 v55, v55
v_sub_f32 v52, v52, v96
v_sub_f32 v53, v53, v97
v_sub_f32 v54, v54, v98
v_sub_f32 v55, v55, v99
v_mul_f32 v52, v52, v127
v_mul_f32 v53, v53, v127
v_mul_f32 v54, v54, v127
v_mul_f32 v55, v55, v127
v_cvt_pk_bf16_f32 v149, v48, v52
v_cvt_pk_bf16_f32 v153, v49, v53
v_cvt_pk_bf16_f32 v157, v50, v54
v_cvt_pk_bf16_f32 v161, v51, v55
s_waitcnt vmcnt(13)
v_cvt_f32_i32 v56, v56
v_cvt_f32_i32 v57, v57
v_cvt_f32_i32 v58, v58
v_cvt_f32_i32 v59, v59
v_sub_f32 v56, v56, v96
v_sub_f32 v57, v57, v97
v_sub_f32 v58, v58, v98
v_sub_f32 v59, v59, v99
v_mul_f32 v56, v56, v128
v_mul_f32 v57, v57, v128
v_mul_f32 v58, v58, v128
v_mul_f32 v59, v59, v128
s_waitcnt vmcnt(11)
v_cvt_f32_i32 v60, v60
v_cvt_f32_i32 v61, v61
v_cvt_f32_i32 v62, v62
v_cvt_f32_i32 v63, v63
v_sub_f32 v60, v60, v96
v_sub_f32 v61, v61, v97
v_sub_f32 v62, v62, v98
v_sub_f32 v63, v63, v99
v_mul_f32 v60, v60, v129
v_mul_f32 v61, v61, v129
v_mul_f32 v62, v62, v129
v_mul_f32 v63, v63, v129
v_cvt_pk_bf16_f32 v150, v56, v60
v_cvt_pk_bf16_f32 v154, v57, v61
v_cvt_pk_bf16_f32 v158, v58, v62
v_cvt_pk_bf16_f32 v162, v59, v63
s_waitcnt vmcnt(9)
v_cvt_f32_i32 v64, v64
v_cvt_f32_i32 v65, v65
v_cvt_f32_i32 v66, v66
v_cvt_f32_i32 v67, v67
v_sub_f32 v64, v64, v96
v_sub_f32 v65, v65, v97
v_sub_f32 v66, v66, v98
v_sub_f32 v67, v67, v99
v_mul_f32 v64, v64, v130
v_mul_f32 v65, v65, v130
v_mul_f32 v66, v66, v130
v_mul_f32 v67, v67, v130
s_waitcnt vmcnt(7)
v_cvt_f32_i32 v68, v68
v_cvt_f32_i32 v69, v69
v_cvt_f32_i32 v70, v70
v_cvt_f32_i32 v71, v71
v_sub_f32 v68, v68, v96
v_sub_f32 v69, v69, v97
v_sub_f32 v70, v70, v98
v_sub_f32 v71, v71, v99
v_mul_f32 v68, v68, v131
v_mul_f32 v69, v69, v131
v_mul_f32 v70, v70, v131
v_mul_f32 v71, v71, v131
v_cvt_pk_bf16_f32 v151, v64, v68
v_cvt_pk_bf16_f32 v155, v65, v69
v_cvt_pk_bf16_f32 v159, v66, v70
v_cvt_pk_bf16_f32 v163, v67, v71
s_mov_b64 exec, s[52:53]
ds_write_b128 v102, v[148:151] offset:14336
ds_write_b128 v103, v[152:155] offset:14336
ds_write_b128 v104, v[156:159] offset:14336
ds_write_b128 v105, v[160:163] offset:14336
s_mov_b64 exec, -1
s_mov_b64 exec, s[52:53]
buffer_store_dwordx4 v[148:151], v164, s[28:31], s83 offen
buffer_store_dwordx4 v[152:155], v165, s[28:31], s83 offen
buffer_store_dwordx4 v[156:159], v166, s[28:31], s83 offen
buffer_store_dwordx4 v[160:163], v167, s[28:31], s83 offen
s_mov_b64 exec, -1
s_add_u32 m0, s44, 32768
s_nop 0
buffer_load_dwordx4 v132, s[20:23], s43 offen offset:0  lds
buffer_load_dwordx4 v133, s[20:23], s43 offen offset:1024  lds
buffer_load_dwordx4 v134, s[20:23], s43 offen offset:2048  lds
buffer_load_dwordx4 v135, s[20:23], s43 offen offset:3072  lds
s_add_u32 m0, s44, 36864
s_nop 0
buffer_load_dwordx4 v136, s[20:23], s43 offen offset:0  lds
buffer_load_dwordx4 v137, s[20:23], s43 offen offset:1024  lds
buffer_load_dwordx4 v138, s[20:23], s43 offen offset:2048  lds
buffer_load_dwordx4 v139, s[20:23], s43 offen offset:3072  lds
s_waitcnt vmcnt(17)
s_mov_b32 s40, 0
L_nonce:
v_readfirstlane_b32 s45, v170
s_nop 3
s_cmp_lg_u32 s45, 0
s_cbranch_scc1 L_gotn
s_add_u32 s40, s40, 1
s_cmp_ge_u32 s40, 128
s_cbranch_scc1 L_non
buffer_load_dwordx2 v[170:171], v178, s[92:95], 0 offen sc1
s_waitcnt vmcnt(0)
s_branch L_nonce
L_non:
s_mov_b32 s57, 1
v_mov_b32 v177, 0x80000000
L_gotn:
v_xor_b32 v171, s59, v171
s_waitcnt vmcnt(8)
s_mov_b64 exec, 1
buffer_store_dwordx2 v[170:171], v177, s[28:31], 0 offen offset:0
s_mov_b64 exec, -1
s_waitcnt lgkmcnt(0)
s_barrier
s_add_u32 m0, s44, 65536
s_nop 0
buffer_load_dwordx4 v132, s[20:23], s82 offen offset:0  lds
buffer_load_dwordx4 v133, s[20:23], s82 offen offset:1024  lds
buffer_load_dwordx4 v134, s[20:23], s82 offen offset:2048  lds
buffer_load_dwordx4 v135, s[20:23], s82 offen offset:3072  lds
s_add_u32 m0, s44, 69632
s_nop 0
buffer_load_dwordx4 v136, s[20:23], s82 offen offset:0  lds
buffer_load_dwordx4 v137, s[20:23], s82 offen offset:1024  lds
buffer_load_dwordx4 v138, s[20:23], s82 offen offset:2048  lds
buffer_load_dwordx4 v139, s[20:23], s82 offen offset:3072  lds
s_waitcnt vmcnt(9)
s_barrier
buffer_load_dword v121, v179, s[28:31], s48 offen
v_readfirstlane_b32 s100, v170
v_readfirstlane_b32 s101, v171
s_lshl_b32 s45, s37, 2
s_add_u32 s45, s45, s38
s_lshl_b32 s45, s45, 8
s_add_u32 s45, s45, 7340032
s_add_u32 s42, s18, s45
s_addc_u32 s43, s19, 0
s_load_dwordx16 s[84:99], s[42:43], 0 glc
s_add_u32 s45, s36, 2
s_and_b32 s45, s45, 7
s_lshl_b32 s47, s45, 7
s_add_u32 s45, s45, s51
s_mul_i32 s63, s45, 14336
s_add_u32 s54, s44, 0
s_add_u32 s55, s44, 4096
s_add_u32 s56, s50, 0
s_mov_b32 m0, s54
s_nop 0
buffer_load_dwordx4 v132, s[20:23], s47 offen offset:0  lds
buffer_load_dwordx4 v133, s[20:23], s47 offen offset:1024  lds
buffer_load_dwordx4 v134, s[20:23], s47 offen offset:2048  lds
buffer_load_dwordx4 v135, s[20:23], s47 offen offset:3072  lds
s_mov_b32 m0, s55
s_nop 0
buffer_load_dwordx4 v136, s[20:23], s47 offen offset:0  lds
buffer_load_dwordx4 v137, s[20:23], s47 offen offset:1024  lds
buffer_load_dwordx4 v138, s[20:23], s47 offen offset:2048  lds
buffer_load_dwordx4 v139, s[20:23], s47 offen offset:3072  lds
s_cmp_lg_u32 s57, 0
s_cbranch_scc1 L_fb2
s_mov_b32 s40, 0
L_pA:
s_waitcnt lgkmcnt(0)
s_xor_b64 s[84:85], s[84:85], s[100:101]
s_xor_b64 s[86:87], s[86:87], s[100:101]
s_xor_b64 s[88:89], s[88:89], s[100:101]
s_xor_b64 s[90:91], s[90:91], s[100:101]
s_xor_b64 s[92:93], s[92:93], s[100:101]
s_xor_b64 s[94:95], s[94:95], s[100:101]
s_xor_b64 s[96:97], s[96:97], s[100:101]
s_xor_b64 s[98:99], s[98:99], s[100:101]
s_or_b64 s[84:85], s[84:85], s[86:87]
s_or_b64 s[84:85], s[84:85], s[88:89]
s_or_b64 s[84:85], s[84:85], s[90:91]
s_or_b64 s[84:85], s[84:85], s[92:93]
s_or_b64 s[84:85], s[84:85], s[94:95]
s_or_b64 s[84:85], s[84:85], s[96:97]
s_or_b64 s[84:85], s[84:85], s[98:99]
s_cmp_eq_u64 s[84:85], 0
s_cbranch_scc1 L_pA_ok
s_add_u32 s40, s40, 1
s_cmp_ge_u32 s40, 128
s_cbranch_scc1 L_fb2
s_load_dwordx16 s[84:99], s[42:43], 0 glc
s_branch L_pA
L_pA_ok:
s_add_u32 s45, s36, 1
s_and_b32 s45, s45, 7
s_lshl_b32 s41, s45, 7
s_add_u32 s45, s45, s51
s_mul_i32 s42, s45, 14336
s_add_u32 s60, s44, 65536
s_add_u32 s61, s44, 69632
s_add_u32 s62, s50, 28672
s_mov_b32 m0, s62
s_nop 0
buffer_load_dwordx4 v168, s[28:31], s42 offen offset:0 sc1 lds
buffer_load_dwordx4 v168, s[28:31], s42 offen offset:1024 sc1 lds
buffer_load_dwordx4 v168, s[28:31], s42 offen offset:2048 sc1 lds
s_mov_b32 exec_hi, 0
buffer_load_dwordx4 v168, s[28:31], s42 offen offset:3072 sc1 lds
s_mov_b32 exec_hi, -1
s_mov_b32 m0, s56
s_nop 0
buffer_load_dwordx4 v168, s[28:31], s63 offen offset:0 sc1 lds
s_add_u32 s45, s36, 3
s_and_b32 s45, s45, 7
s_lshl_b32 s41, s45, 7
s_add_u32 s45, s45, s51
buffer_load_dwordx4 v168, s[28:31], s63 offen offset:1024 sc1 lds
s_mul_i32 s42, s45, 14336
s_add_u32 s60, s44, 32768
s_add_u32 s61, s44, 36864
s_add_u32 s62, s50, 14336
buffer_load_dwordx4 v168, s[28:31], s63 offen offset:2048 sc1 lds
s_mov_b32 exec_hi, 0
buffer_load_dwordx4 v168, s[28:31], s63 offen offset:3072 sc1 lds
s_mov_b32 exec_hi, -1
s_waitcnt vmcnt(4)
s_barrier
s_mov_b32 m0, s62
s_nop 0
buffer_load_dwordx4 v168, s[28:31], s42 offen offset:0 sc1 lds
buffer_load_dwordx4 v168, s[28:31], s42 offen offset:1024 sc1 lds
s_add_u32 s45, s36, 4
buffer_load_dwordx4 v168, s[28:31], s42 offen offset:2048 sc1 lds
s_and_b32 s45, s45, 7
s_mov_b32 exec_hi, 0
buffer_load_dwordx4 v168, s[28:31], s42 offen offset:3072 sc1 lds
s_mov_b32 exec_hi, -1
s_lshl_b32 s47, s45, 7
s_mov_b32 m0, s60
s_nop 0
buffer_load_dwordx4 v132, s[20:23], s41 offen offset:0  lds
s_add_u32 s45, s45, s51
buffer_load_dwordx4 v133, s[20:23], s41 offen offset:1024  lds
buffer_load_dwordx4 v134, s[20:23], s41 offen offset:2048  lds
s_mul_i32 s63, s45, 14336
buffer_load_dwordx4 v135, s[20:23], s41 offen offset:3072  lds
s_add_u32 s54, s44, 65536
s_mov_b32 m0, s61
s_nop 0
buffer_load_dwordx4 v136, s[20:23], s41 offen offset:0  lds
s_add_u32 s55, s44, 69632
buffer_load_dwordx4 v137, s[20:23], s41 offen offset:1024  lds
s_add_u32 s56, s50, 28672
buffer_load_dwordx4 v138, s[20:23], s41 offen offset:2048  lds
buffer_load_dwordx4 v139, s[20:23], s41 offen offset:3072  lds
s_waitcnt vmcnt(12)
s_barrier
s_mov_b32 m0, s56
s_nop 0
buffer_load_dwordx4 v168, s[28:31], s63 offen offset:0 sc1 lds
buffer_load_dwordx4 v168, s[28:31], s63 offen offset:1024 sc1 lds
s_add_u32 s45, s36, 5
buffer_load_dwordx4 v168, s[28:31], s63 offen offset:2048 sc1 lds
s_and_b32 s45, s45, 7
s_mov_b32 exec_hi, 0
buffer_load_dwordx4 v168, s[28:31], s63 offen offset:3072 sc1 lds
s_mov_b32 exec_hi, -1
s_lshl_b32 s41, s45, 7
s_mov_b32 m0, s54
s_nop 0
buffer_load_dwordx4 v132, s[20:23], s47 offen offset:0  lds
s_add_u32 s45, s45, s51
buffer_load_dwordx4 v133, s[20:23], s47 offen offset:1024  lds
buffer_load_dwordx4 v134, s[20:23], s47 offen offset:2048  lds
s_mul_i32 s42, s45, 14336
buffer_load_dwordx4 v135, s[20:23], s47 offen offset:3072  lds
s_add_u32 s60, s44, 0
s_mov_b32 m0, s55
s_nop 0
buffer_load_dwordx4 v136, s[20:23], s47 offen offset:0  lds
s_add_u32 s61, s44, 4096
buffer_load_dwordx4 v137, s[20:23], s47 offen offset:1024  lds
s_add_u32 s62, s50, 0
buffer_load_dwordx4 v138, s[20:23], s47 offen offset:2048  lds
buffer_load_dwordx4 v139, s[20:23], s47 offen offset:3072  lds
buffer_load_dword v120, v176, s[20:23], 0 offen
s_waitcnt vmcnt(13)
s_barrier
s_mov_b32 m0, s62
s_nop 0
buffer_load_dwordx4 v168, s[28:31], s42 offen offset:0 sc1 lds
buffer_load_dwordx4 v168, s[28:31], s42 offen offset:1024 sc1 lds
s_add_u32 s45, s36, 6
buffer_load_dwordx4 v168, s[28:31], s42 offen offset:2048 sc1 lds
s_and_b32 s45, s45, 7
s_mov_b32 exec_hi, 0
buffer_load_dwordx4 v168, s[28:31], s42 offen offset:3072 sc1 lds
s_mov_b32 exec_hi, -1
s_lshl_b32 s47, s45, 7
s_mov_b32 m0, s60
s_nop 0
buffer_load_dwordx4 v132, s[20:23], s41 offen offset:0  lds
s_add_u32 s45, s45, s51
buffer_load_dwordx4 v133, s[20:23], s41 offen offset:1024  lds
buffer_load_dwordx4 v134, s[20:23], s41 offen offset:2048  lds
s_mul_i32 s63, s45, 14336
buffer_load_dwordx4 v135, s[20:23], s41 offen offset:3072  lds
s_add_u32 s54, s44, 32768
s_mov_b32 m0, s61
s_nop 0
buffer_load_dwordx4 v136, s[20:23], s41 offen offset:0  lds
s_add_u32 s55, s44, 36864
buffer_load_dwordx4 v137, s[20:23], s41 offen offset:1024  lds
s_add_u32 s56, s50, 14336
buffer_load_dwordx4 v138, s[20:23], s41 offen offset:2048  lds
buffer_load_dwordx4 v139, s[20:23], s41 offen offset:3072  lds
s_waitcnt vmcnt(13)
s_barrier
s_mov_b32 m0, s56
s_nop 0
buffer_load_dwordx4 v168, s[28:31], s63 offen offset:0 sc1 lds
buffer_load_dwordx4 v168, s[28:31], s63 offen offset:1024 sc1 lds
s_add_u32 s45, s36, 7
buffer_load_dwordx4 v168, s[28:31], s63 offen offset:2048 sc1 lds
s_and_b32 s45, s45, 7
s_mov_b32 exec_hi, 0
buffer_load_dwordx4 v168, s[28:31], s63 offen offset:3072 sc1 lds
s_mov_b32 exec_hi, -1
s_lshl_b32 s41, s45, 7
s_mov_b32 m0, s54
s_nop 0
buffer_load_dwordx4 v132, s[20:23], s47 offen offset:0  lds
s_add_u32 s45, s45, s51
buffer_load_dwordx4 v133, s[20:23], s47 offen offset:1024  lds
buffer_load_dwordx4 v134, s[20:23], s47 offen offset:2048  lds
s_mul_i32 s42, s45, 14336
buffer_load_dwordx4 v135, s[20:23], s47 offen offset:3072  lds
s_add_u32 s60, s44, 65536
s_mov_b32 m0, s55
s_nop 0
buffer_load_dwordx4 v136, s[20:23], s47 offen offset:0  lds
s_add_u32 s61, s44, 69632
buffer_load_dwordx4 v137, s[20:23], s47 offen offset:1024  lds
s_add_u32 s62, s50, 28672
buffer_load_dwordx4 v138, s[20:23], s47 offen offset:2048  lds
buffer_load_dwordx4 v139, s[20:23], s47 offen offset:3072  lds
s_waitcnt vmcnt(12)
s_barrier
s_mov_b32 m0, s62
s_nop 0
buffer_load_dwordx4 v168, s[28:31], s42 offen offset:0 sc1 lds
buffer_load_dwordx4 v168, s[28:31], s42 offen offset:1024 sc1 lds
s_add_u32 s45, s36, 9
buffer_load_dwordx4 v168, s[28:31], s42 offen offset:2048 sc1 lds
s_and_b32 s45, s45, 7
s_mov_b32 exec_hi, 0
buffer_load_dwordx4 v168, s[28:31], s42 offen offset:3072 sc1 lds
s_mov_b32 exec_hi, -1
s_or_b32 s45, s45, 8
s_mov_b32 m0, s60
s_nop 0
buffer_load_dwordx4 v132, s[20:23], s41 offen offset:0  lds
s_lshl_b32 s47, s45, 7
buffer_load_dwordx4 v133, s[20:23], s41 offen offset:1024  lds
s_add_u32 s45, s45, s51
buffer_load_dwordx4 v134, s[20:23], s41 offen offset:2048  lds
s_mul_i32 s63, s45, 14336
buffer_load_dwordx4 v135, s[20:23], s41 offen offset:3072  lds
s_add_u32 s54, s44, 0
s_mov_b32 m0, s61
s_nop 0
buffer_load_dwordx4 v136, s[20:23], s41 offen offset:0  lds
s_add_u32 s55, s44, 4096
buffer_load_dwordx4 v137, s[20:23], s41 offen offset:1024  lds
s_add_u32 s56, s50, 0
buffer_load_dwordx4 v138, s[20:23], s41 offen offset:2048  lds
buffer_load_dwordx4 v139, s[20:23], s41 offen offset:3072  lds
s_waitcnt vmcnt(12)
s_barrier
s_mov_b32 m0, s56
s_nop 0
buffer_load_dwordx4 v168, s[28:31], s63 offen offset:0 sc1 lds
buffer_load_dwordx4 v168, s[28:31], s63 offen offset:1024 sc1 lds
s_add_u32 s45, s36, 10
buffer_load_dwordx4 v168, s[28:31], s63 offen offset:2048 sc1 lds
s_and_b32 s45, s45, 7
s_mov_b32 exec_hi, 0
buffer_load_dwordx4 v168, s[28:31], s63 offen offset:3072 sc1 lds
s_mov_b32 exec_hi, -1
s_or_b32 s45, s45, 8
s_mov_b32 m0, s54
s_nop 0
buffer_load_dwordx4 v132, s[20:23], s47 offen offset:0  lds
s_lshl_b32 s41, s45, 7
buffer_load_dwordx4 v133, s[20:23], s47 offen offset:1024  lds
s_add_u32 s45, s45, s51
buffer_load_dwordx4 v134, s[20:23], s47 offen offset:2048  lds
s_mul_i32 s42, s45, 14336
buffer_load_dwordx4 v135, s[20:23], s47 offen offset:3072  lds
s_add_u32 s60, s44, 32768
s_mov_b32 m0, s55
s_nop 0
buffer_load_dwordx4 v136, s[20:23], s47 offen offset:0  lds
s_add_u32 s61, s44, 36864
buffer_load_dwordx4 v137, s[20:23], s47 offen offset:1024  lds
s_add_u32 s62, s50, 14336
buffer_load_dwordx4 v138, s[20:23], s47 offen offset:2048  lds
buffer_load_dwordx4 v139, s[20:23], s47 offen offset:3072  lds
s_waitcnt vmcnt(12)
s_barrier
s_mov_b32 m0, s62
s_nop 0
buffer_load_dwordx4 v168, s[28:31], s42 offen offset:0 sc1 lds
buffer_load_dwordx4 v168, s[28:31], s42 offen offset:1024 sc1 lds
s_add_u32 s45, s36, 11
buffer_load_dwordx4 v168, s[28:31], s42 offen offset:2048 sc1 lds
s_and_b32 s45, s45, 7
s_mov_b32 exec_hi, 0
buffer_load_dwordx4 v168, s[28:31], s42 offen offset:3072 sc1 lds
s_mov_b32 exec_hi, -1
s_or_b32 s45, s45, 8
s_mov_b32 m0, s60
s_nop 0
buffer_load_dwordx4 v132, s[20:23], s41 offen offset:0  lds
s_lshl_b32 s47, s45, 7
buffer_load_dwordx4 v133, s[20:23], s41 offen offset:1024  lds
s_add_u32 s45, s45, s51
buffer_load_dwordx4 v134, s[20:23], s41 offen offset:2048  lds
s_mul_i32 s63, s45, 14336
buffer_load_dwordx4 v135, s[20:23], s41 offen offset:3072  lds
s_add_u32 s54, s44, 65536
s_mov_b32 m0, s61
s_nop 0
buffer_load_dwordx4 v136, s[20:23], s41 offen offset:0  lds
s_add_u32 s55, s44, 69632
buffer_load_dwordx4 v137, s[20:23], s41 offen offset:1024  lds
s_add_u32 s56, s50, 28672
buffer_load_dwordx4 v138, s[20:23], s41 offen offset:2048  lds
buffer_load_dwordx4 v139, s[20:23], s41 offen offset:3072  lds
s_waitcnt vmcnt(12)
s_barrier
s_mov_b32 m0, s56
s_nop 0
buffer_load_dwordx4 v168, s[28:31], s63 offen offset:0 sc1 lds
buffer_load_dwordx4 v168, s[28:31], s63 offen offset:1024 sc1 lds
s_add_u32 s45, s36, 12
buffer_load_dwordx4 v168, s[28:31], s63 offen offset:2048 sc1 lds
s_and_b32 s45, s45, 7
s_mov_b32 exec_hi, 0
buffer_load_dwordx4 v168, s[28:31], s63 offen offset:3072 sc1 lds
s_mov_b32 exec_hi, -1
s_or_b32 s45, s45, 8
s_mov_b32 m0, s54
s_nop 0
buffer_load_dwordx4 v132, s[20:23], s47 offen offset:0  lds
s_lshl_b32 s41, s45, 7
buffer_load_dwordx4 v133, s[20:23], s47 offen offset:1024  lds
s_add_u32 s45, s45, s51
buffer_load_dwordx4 v134, s[20:23], s47 offen offset:2048  lds
s_mul_i32 s42, s45, 14336
buffer_load_dwordx4 v135, s[20:23], s47 offen offset:3072  lds
s_add_u32 s60, s44, 0
s_mov_b32 m0, s55
s_nop 0
buffer_load_dwordx4 v136, s[20:23], s47 offen offset:0  lds
s_add_u32 s61, s44, 4096
buffer_load_dwordx4 v137, s[20:23], s47 offen offset:1024  lds
s_add_u32 s62, s50, 0
buffer_load_dwordx4 v138, s[20:23], s47 offen offset:2048  lds
buffer_load_dwordx4 v139, s[20:23], s47 offen offset:3072  lds
s_waitcnt vmcnt(12)
s_barrier
s_mov_b32 m0, s62
s_nop 0
buffer_load_dwordx4 v168, s[28:31], s42 offen offset:0 sc1 lds
buffer_load_dwordx4 v168, s[28:31], s42 offen offset:1024 sc1 lds
s_add_u32 s45, s36, 13
buffer_load_dwordx4 v168, s[28:31], s42 offen offset:2048 sc1 lds
s_and_b32 s45, s45, 7
s_mov_b32 exec_hi, 0
buffer_load_dwordx4 v168, s[28:31], s42 offen offset:3072 sc1 lds
s_mov_b32 exec_hi, -1
s_or_b32 s45, s45, 8
s_mov_b32 m0, s60
s_nop 0
buffer_load_dwordx4 v132, s[20:23], s41 offen offset:0  lds
s_lshl_b32 s47, s45, 7
buffer_load_dwordx4 v133, s[20:23], s41 offen offset:1024  lds
s_add_u32 s45, s45, s51
buffer_load_dwordx4 v134, s[20:23], s41 offen offset:2048  lds
s_mul_i32 s63, s45, 14336
buffer_load_dwordx4 v135, s[20:23], s41 offen offset:3072  lds
s_add_u32 s54, s44, 32768
s_mov_b32 m0, s61
s_nop 0
buffer_load_dwordx4 v136, s[20:23], s41 offen offset:0  lds
s_add_u32 s55, s44, 36864
buffer_load_dwordx4 v137, s[20:23], s41 offen offset:1024  lds
s_add_u32 s56, s50, 14336
buffer_load_dwordx4 v138, s[20:23], s41 offen offset:2048  lds
buffer_load_dwordx4 v139, s[20:23], s41 offen offset:3072  lds
s_waitcnt vmcnt(12)
s_barrier
s_mov_b32 m0, s56
s_nop 0
buffer_load_dwordx4 v168, s[28:31], s63 offen offset:0 sc1 lds
buffer_load_dwordx4 v168, s[28:31], s63 offen offset:1024 sc1 lds
s_add_u32 s45, s36, 14
buffer_load_dwordx4 v168, s[28:31], s63 offen offset:2048 sc1 lds
s_and_b32 s45, s45, 7
s_mov_b32 exec_hi, 0
buffer_load_dwordx4 v168, s[28:31], s63 offen offset:3072 sc1 lds
s_mov_b32 exec_hi, -1
s_or_b32 s45, s45, 8
s_mov_b32 m0, s54
s_nop 0
buffer_load_dwordx4 v132, s[20:23], s47 offen offset:0  lds
s_lshl_b32 s41, s45, 7
buffer_load_dwordx4 v133, s[20:23], s47 offen offset:1024  lds
s_add_u32 s45, s45, s51
buffer_load_dwordx4 v134, s[20:23], s47 offen offset:2048  lds
s_mul_i32 s42, s45, 14336
buffer_load_dwordx4 v135, s[20:23], s47 offen offset:3072  lds
s_add_u32 s60, s44, 65536
s_mov_b32 m0, s55
s_nop 0
buffer_load_dwordx4 v136, s[20:23], s47 offen offset:0  lds
s_add_u32 s61, s44, 69632
buffer_load_dwordx4 v137, s[20:23], s47 offen offset:1024  lds
s_add_u32 s62, s50, 28672
buffer_load_dwordx4 v138, s[20:23], s47 offen offset:2048  lds
buffer_load_dwordx4 v139, s[20:23], s47 offen offset:3072  lds
s_waitcnt vmcnt(12)
s_barrier
s_mov_b32 m0, s62
s_nop 0
buffer_load_dwordx4 v168, s[28:31], s42 offen offset:0 sc1 lds
buffer_load_dwordx4 v168, s[28:31], s42 offen offset:1024 sc1 lds
s_add_u32 s45, s36, 15
buffer_load_dwordx4 v168, s[28:31], s42 offen offset:2048 sc1 lds
s_and_b32 s45, s45, 7
s_mov_b32 exec_hi, 0
buffer_load_dwordx4 v168, s[28:31], s42 offen offset:3072 sc1 lds
s_mov_b32 exec_hi, -1
s_or_b32 s45, s45, 8
s_mov_b32 m0, s60
s_nop 0
buffer_load_dwordx4 v132, s[20:23], s41 offen offset:0  lds
s_lshl_b32 s47, s45, 7
buffer_load_dwordx4 v133, s[20:23], s41 offen offset:1024  lds
s_add_u32 s45, s45, s51
buffer_load_dwordx4 v134, s[20:23], s41 offen offset:2048  lds
s_mul_i32 s63, s45, 14336
buffer_load_dwordx4 v135, s[20:23], s41 offen offset:3072  lds
s_add_u32 s54, s44, 0
s_mov_b32 m0, s61
s_nop 0
buffer_load_dwordx4 v136, s[20:23], s41 offen offset:0  lds
s_add_u32 s55, s44, 4096
buffer_load_dwordx4 v137, s[20:23], s41 offen offset:1024  lds
s_add_u32 s56, s50, 0
buffer_load_dwordx4 v138, s[20:23], s41 offen offset:2048  lds
buffer_load_dwordx4 v139, s[20:23], s41 offen offset:3072  lds
s_waitcnt vmcnt(12)
s_barrier
s_mov_b32 m0, s56
s_nop 0
buffer_load_dwordx4 v168, s[28:31], s63 offen offset:0 sc1 lds
buffer_load_dwordx4 v168, s[28:31], s63 offen offset:1024 sc1 lds
buffer_load_dwordx4 v168, s[28:31], s63 offen offset:2048 sc1 lds
s_mov_b32 exec_hi, 0
buffer_load_dwordx4 v168, s[28:31], s63 offen offset:3072 sc1 lds
s_mov_b32 exec_hi, -1
s_mov_b32 m0, s54
s_nop 0
buffer_load_dwordx4 v132, s[20:23], s47 offen offset:0  lds
buffer_load_dwordx4 v133, s[20:23], s47 offen offset:1024  lds
buffer_load_dwordx4 v134, s[20:23], s47 offen offset:2048  lds
buffer_load_dwordx4 v135, s[20:23], s47 offen offset:3072  lds
s_mov_b32 m0, s55
s_nop 0
buffer_load_dwordx4 v136, s[20:23], s47 offen offset:0  lds
buffer_load_dwordx4 v137, s[20:23], s47 offen offset:1024  lds
buffer_load_dwordx4 v138, s[20:23], s47 offen offset:2048  lds
buffer_load_dwordx4 v139, s[20:23], s47 offen offset:3072  lds
s_waitcnt vmcnt(12)
s_barrier
s_waitcnt vmcnt(0)
s_barrier
L_fin:
s_endpgm
L_consumer:
s_memrealtime s[82:83]
v_and_b32 v3, 15, v2
v_lshrrev_b32 v4, 4, v2
v_and_b32 v5, 7, v3
v_xor_b32 v5, v5, v4
v_lshlrev_b32 v5, 4, v5
v_lshl_add_u32 v5, v3, 7, v5
s_lshl_b32 s41, s38, 13
v_add_u32 v200, s41, v5
v_xor_b32 v201, 64, v200
v_add_u32 v202, 0x10000, v200
v_add_u32 v203, 0x10000, v201
v_mul_u32_u24 v5, 1792, v4
v_add_u32 v5, 98304, v5
v_lshl_add_u32 v204, v3, 4, v5
v_and_b32 v6, 1, v3
v_lshrrev_b32 v7, 1, v3
v_lshl_add_u32 v6, v6, 3, v7
v_lshl_add_u32 v205, v6, 4, v5
v_and_b32 v6, 3, v3
v_lshrrev_b32 v7, 2, v3
v_lshl_add_u32 v6, v6, 2, v7
v_lshl_add_u32 v206, v6, 4, v5
s_lshl_b32 s41, s36, 8
s_lshl_b32 s42, s38, 6
s_add_u32 s41, s41, s42
s_mul_i32 s41, s41, 7168
s_mul_i32 s42, s37, 224
s_add_u32 s41, s41, s42
s_and_b32 s45, s37, 3
s_lshl_b32 s54, s45, 5
s_add_u32 s55, s54, 128
s_sub_u32 s56, s54, 64
s_cmp_ge_u32 s45, 2
s_cselect_b32 s55, s56, s55
s_bitcmp1_b32 s45, 0
s_cselect_b32 s56, 0, 192
v_mul_u32_u24 v5, 28672, v4
v_add_u32 v5, s41, v5
v_lshl_add_u32 v216, v3, 3, v5
v_lshl_add_u32 v217, v3, 2, v5
v_lshl_add_u32 v218, v3, 1, v5
v_add_u32 v216, s54, v216
v_add_u32 v217, s55, v217
v_add_u32 v218, s56, v218
s_add_u32 s54, s54, s42
s_add_u32 s55, s55, s42
s_add_u32 s56, s56, s42
v_lshl_add_u32 v6, v3, 3, s54
v_lshl_add_u32 v7, v3, 2, s55
v_lshl_add_u32 v8, v3, 1, s56
s_lshl_b32 s43, s37, 3
v_mov_b32 v9, s43
s_or_b32 s44, s36, s38
s_waitcnt lgkmcnt(0)
s_cmp_lg_u32 s44, 0
s_cbranch_scc1 L_nonon
s_mov_b32 s92, s16
s_mov_b32 s93, s17
s_mov_b32 s94, 256
s_mov_b32 s95, 0x20000
s_or_b32 s82, s82, 1
v_mov_b32 v10, s82
v_mov_b32 v11, s83
s_mov_b64 exec, 1
buffer_store_dwordx2 v[10:11], v9, s[92:95], 0 offen sc1
s_mov_b64 exec, -1
L_nonon:
s_mov_b32 s84, s8
s_mov_b32 s85, s9
s_mov_b32 s86, 7168
s_mov_b32 s87, 0x20000
s_mov_b32 s32, s14
s_mov_b32 s33, s15
s_mov_b32 s34, 14680064
s_mov_b32 s35, 0x20000
buffer_load_dwordx2 v[220:221], v6, s[84:87], 0 offen
buffer_load_dword v222, v7, s[84:87], 0 offen
buffer_load_ushort v223, v8, s[84:87], 0 offen
v_mov_b32 v0, 0
v_mov_b32 v1, 0
v_mov_b32 v2, 0
v_mov_b32 v3, 0
v_mov_b32 v4, 0
v_mov_b32 v5, 0
v_mov_b32 v6, 0
v_mov_b32 v7, 0
v_mov_b32 v8, 0
v_mov_b32 v9, 0
v_mov_b32 v10, 0
v_mov_b32 v11, 0
v_mov_b32 v12, 0
v_mov_b32 v13, 0
v_mov_b32 v14, 0
v_mov_b32 v15, 0
v_mov_b32 v16, 0
v_mov_b32 v17, 0
v_mov_b32 v18, 0
v_mov_b32 v19, 0
v_mov_b32 v20, 0
v_mov_b32 v21, 0
v_mov_b32 v22, 0
v_mov_b32 v23, 0
v_mov_b32 v24, 0
v_mov_b32 v25, 0
v_mov_b32 v26, 0
v_mov_b32 v27, 0
v_mov_b32 v28, 0
v_mov_b32 v29, 0
v_mov_b32 v30, 0
v_mov_b32 v31, 0
v_mov_b32 v32, 0
v_mov_b32 v33, 0
v_mov_b32 v34, 0
v_mov_b32 v35, 0
v_mov_b32 v36, 0
v_mov_b32 v37, 0
v_mov_b32 v38, 0
v_mov_b32 v39, 0
v_mov_b32 v40, 0
v_mov_b32 v41, 0
v_mov_b32 v42, 0
v_mov_b32 v43, 0
v_mov_b32 v44, 0
v_mov_b32 v45, 0
v_mov_b32 v46, 0
v_mov_b32 v47, 0
v_mov_b32 v48, 0
v_mov_b32 v49, 0
v_mov_b32 v50, 0
v_mov_b32 v51, 0
v_mov_b32 v52, 0
v_mov_b32 v53, 0
v_mov_b32 v54, 0
v_mov_b32 v55, 0
v_mov_b32 v56, 0
v_mov_b32 v57, 0
v_mov_b32 v58, 0
v_mov_b32 v59, 0
v_mov_b32 v60, 0
v_mov_b32 v61, 0
v_mov_b32 v62, 0
v_mov_b32 v63, 0
v_mov_b32 v64, 0
v_mov_b32 v65, 0
v_mov_b32 v66, 0
v_mov_b32 v67, 0
v_mov_b32 v68, 0
v_mov_b32 v69, 0
v_mov_b32 v70, 0
v_mov_b32 v71, 0
v_mov_b32 v72, 0
v_mov_b32 v73, 0
v_mov_b32 v74, 0
v_mov_b32 v75, 0
v_mov_b32 v76, 0
v_mov_b32 v77, 0
v_mov_b32 v78, 0
v_mov_b32 v79, 0
v_mov_b32 v80, 0
v_mov_b32 v81, 0
v_mov_b32 v82, 0
v_mov_b32 v83, 0
v_mov_b32 v84, 0
v_mov_b32 v85, 0
v_mov_b32 v86, 0
v_mov_b32 v87, 0
v_mov_b32 v88, 0
v_mov_b32 v89, 0
v_mov_b32 v90, 0
v_mov_b32 v91, 0
v_mov_b32 v92, 0
v_mov_b32 v93, 0
v_mov_b32 v94, 0
v_mov_b32 v95, 0
v_mov_b32 v96, 0
v_mov_b32 v97, 0
v_mov_b32 v98, 0
v_mov_b32 v99, 0
v_mov_b32 v100, 0
v_mov_b32 v101, 0
v_mov_b32 v102, 0
v_mov_b32 v103, 0
v_mov_b32 v104, 0
v_mov_b32 v105, 0
v_mov_b32 v106, 0
v_mov_b32 v107, 0
v_mov_b32 v108, 0
v_mov_b32 v109, 0
v_mov_b32 v110, 0
v_mov_b32 v111, 0
s_waitcnt vmcnt(0)
v_lshlrev_b32 v208, 16, v220
v_and_b32 v209, 0xffff0000, v220
v_lshlrev_b32 v210, 16, v221
v_and_b32 v211, 0xffff0000, v221
v_lshlrev_b32 v212, 16, v222
v_and_b32 v213, 0xffff0000, v222
v_lshlrev_b32 v214, 16, v223
s_mov_b32 s40, 0
s_barrier
ds_read_b128 v[112:115], v200 offset:0
ds_read_b128 v[128:131], v204 offset:0
ds_read_b128 v[116:119], v200 offset:2048
ds_read_b128 v[120:123], v200 offset:4096
ds_read_b128 v[124:127], v200 offset:6144
ds_read_b128 v[132:135], v204 offset:256
ds_read_b128 v[136:139], v204 offset:512
ds_read_b128 v[140:143], v204 offset:768
ds_read_b128 v[144:147], v205 offset:1024
ds_read_b128 v[148:151], v205 offset:1280
ds_read_b128 v[152:155], v206 offset:1536
s_waitcnt lgkmcnt(0)
L_cons:
v_mfma_f32_16x16x32_bf16 v[0:3], v[112:115], v[128:131], v[0:3]
ds_read_b128 v[156:159], v201 offset:0
v_mfma_f32_16x16x32_bf16 v[28:31], v[116:119], v[128:131], v[28:31]
v_mfma_f32_16x16x32_bf16 v[56:59], v[120:123], v[128:131], v[56:59]
ds_read_b128 v[172:175], v204 offset:7168
v_mfma_f32_16x16x32_bf16 v[84:87], v[124:127], v[128:131], v[84:87]
v_mfma_f32_16x16x32_bf16 v[4:7], v[112:115], v[132:135], v[4:7]
ds_read_b128 v[160:163], v201 offset:2048
v_mfma_f32_16x16x32_bf16 v[32:35], v[116:119], v[132:135], v[32:35]
v_mfma_f32_16x16x32_bf16 v[60:63], v[120:123], v[132:135], v[60:63]
ds_read_b128 v[164:167], v201 offset:4096
v_mfma_f32_16x16x32_bf16 v[88:91], v[124:127], v[132:135], v[88:91]
v_mfma_f32_16x16x32_bf16 v[8:11], v[112:115], v[136:139], v[8:11]
ds_read_b128 v[168:171], v201 offset:6144
v_mfma_f32_16x16x32_bf16 v[36:39], v[116:119], v[136:139], v[36:39]
v_mfma_f32_16x16x32_bf16 v[64:67], v[120:123], v[136:139], v[64:67]
ds_read_b128 v[176:179], v204 offset:7424
v_mfma_f32_16x16x32_bf16 v[92:95], v[124:127], v[136:139], v[92:95]
v_mfma_f32_16x16x32_bf16 v[12:15], v[112:115], v[140:143], v[12:15]
ds_read_b128 v[180:183], v204 offset:7680
v_mfma_f32_16x16x32_bf16 v[40:43], v[116:119], v[140:143], v[40:43]
v_mfma_f32_16x16x32_bf16 v[68:71], v[120:123], v[140:143], v[68:71]
ds_read_b128 v[184:187], v204 offset:7936
v_mfma_f32_16x16x32_bf16 v[96:99], v[124:127], v[140:143], v[96:99]
v_mfma_f32_16x16x32_bf16 v[16:19], v[112:115], v[144:147], v[16:19]
ds_read_b128 v[188:191], v205 offset:8192
v_mfma_f32_16x16x32_bf16 v[44:47], v[116:119], v[144:147], v[44:47]
v_mfma_f32_16x16x32_bf16 v[72:75], v[120:123], v[144:147], v[72:75]
ds_read_b128 v[192:195], v205 offset:8448
v_mfma_f32_16x16x32_bf16 v[100:103], v[124:127], v[144:147], v[100:103]
v_mfma_f32_16x16x32_bf16 v[20:23], v[112:115], v[148:151], v[20:23]
ds_read_b128 v[196:199], v206 offset:8704
v_mfma_f32_16x16x32_bf16 v[48:51], v[116:119], v[148:151], v[48:51]
v_mfma_f32_16x16x32_bf16 v[76:79], v[120:123], v[148:151], v[76:79]
v_mfma_f32_16x16x32_bf16 v[104:107], v[124:127], v[148:151], v[104:107]
v_mfma_f32_16x16x32_bf16 v[24:27], v[112:115], v[152:155], v[24:27]
v_mfma_f32_16x16x32_bf16 v[52:55], v[116:119], v[152:155], v[52:55]
v_mfma_f32_16x16x32_bf16 v[80:83], v[120:123], v[152:155], v[80:83]
v_mfma_f32_16x16x32_bf16 v[108:111], v[124:127], v[152:155], v[108:111]
s_waitcnt lgkmcnt(0)
s_barrier
v_mfma_f32_16x16x32_bf16 v[0:3], v[156:159], v[172:175], v[0:3]
ds_read_b128 v[112:115], v200 offset:32768
v_mfma_f32_16x16x32_bf16 v[28:31], v[160:163], v[172:175], v[28:31]
v_mfma_f32_16x16x32_bf16 v[56:59], v[164:167], v[172:175], v[56:59]
ds_read_b128 v[128:131], v204 offset:14336
v_mfma_f32_16x16x32_bf16 v[84:87], v[168:171], v[172:175], v[84:87]
v_mfma_f32_16x16x32_bf16 v[4:7], v[156:159], v[176:179], v[4:7]
ds_read_b128 v[116:119], v200 offset:34816
v_mfma_f32_16x16x32_bf16 v[32:35], v[160:163], v[176:179], v[32:35]
v_mfma_f32_16x16x32_bf16 v[60:63], v[164:167], v[176:179], v[60:63]
ds_read_b128 v[120:123], v200 offset:36864
v_mfma_f32_16x16x32_bf16 v[88:91], v[168:171], v[176:179], v[88:91]
v_mfma_f32_16x16x32_bf16 v[8:11], v[156:159], v[180:183], v[8:11]
ds_read_b128 v[124:127], v200 offset:38912
v_mfma_f32_16x16x32_bf16 v[36:39], v[160:163], v[180:183], v[36:39]
v_mfma_f32_16x16x32_bf16 v[64:67], v[164:167], v[180:183], v[64:67]
ds_read_b128 v[132:135], v204 offset:14592
v_mfma_f32_16x16x32_bf16 v[92:95], v[168:171], v[180:183], v[92:95]
v_mfma_f32_16x16x32_bf16 v[12:15], v[156:159], v[184:187], v[12:15]
ds_read_b128 v[136:139], v204 offset:14848
v_mfma_f32_16x16x32_bf16 v[40:43], v[160:163], v[184:187], v[40:43]
v_mfma_f32_16x16x32_bf16 v[68:71], v[164:167], v[184:187], v[68:71]
ds_read_b128 v[140:143], v204 offset:15104
v_mfma_f32_16x16x32_bf16 v[96:99], v[168:171], v[184:187], v[96:99]
v_mfma_f32_16x16x32_bf16 v[16:19], v[156:159], v[188:191], v[16:19]
ds_read_b128 v[144:147], v205 offset:15360
v_mfma_f32_16x16x32_bf16 v[44:47], v[160:163], v[188:191], v[44:47]
v_mfma_f32_16x16x32_bf16 v[72:75], v[164:167], v[188:191], v[72:75]
ds_read_b128 v[148:151], v205 offset:15616
v_mfma_f32_16x16x32_bf16 v[100:103], v[168:171], v[188:191], v[100:103]
v_mfma_f32_16x16x32_bf16 v[20:23], v[156:159], v[192:195], v[20:23]
ds_read_b128 v[152:155], v206 offset:15872
v_mfma_f32_16x16x32_bf16 v[48:51], v[160:163], v[192:195], v[48:51]
v_mfma_f32_16x16x32_bf16 v[76:79], v[164:167], v[192:195], v[76:79]
v_mfma_f32_16x16x32_bf16 v[104:107], v[168:171], v[192:195], v[104:107]
v_mfma_f32_16x16x32_bf16 v[24:27], v[156:159], v[196:199], v[24:27]
s_add_u32 s40, s40, 1
s_cmp_eq_u32 s40, 5
v_mfma_f32_16x16x32_bf16 v[52:55], v[160:163], v[196:199], v[52:55]
v_mfma_f32_16x16x32_bf16 v[80:83], v[164:167], v[196:199], v[80:83]
v_mfma_f32_16x16x32_bf16 v[108:111], v[168:171], v[196:199], v[108:111]
s_waitcnt lgkmcnt(0)
s_cbranch_scc1 L_tail
v_mfma_f32_16x16x32_bf16 v[0:3], v[112:115], v[128:131], v[0:3]
ds_read_b128 v[156:159], v201 offset:32768
v_mfma_f32_16x16x32_bf16 v[28:31], v[116:119], v[128:131], v[28:31]
v_mfma_f32_16x16x32_bf16 v[56:59], v[120:123], v[128:131], v[56:59]
ds_read_b128 v[172:175], v204 offset:21504
v_mfma_f32_16x16x32_bf16 v[84:87], v[124:127], v[128:131], v[84:87]
v_mfma_f32_16x16x32_bf16 v[4:7], v[112:115], v[132:135], v[4:7]
ds_read_b128 v[160:163], v201 offset:34816
v_mfma_f32_16x16x32_bf16 v[32:35], v[116:119], v[132:135], v[32:35]
v_mfma_f32_16x16x32_bf16 v[60:63], v[120:123], v[132:135], v[60:63]
ds_read_b128 v[164:167], v201 offset:36864
v_mfma_f32_16x16x32_bf16 v[88:91], v[124:127], v[132:135], v[88:91]
v_mfma_f32_16x16x32_bf16 v[8:11], v[112:115], v[136:139], v[8:11]
ds_read_b128 v[168:171], v201 offset:38912
v_mfma_f32_16x16x32_bf16 v[36:39], v[116:119], v[136:139], v[36:39]
v_mfma_f32_16x16x32_bf16 v[64:67], v[120:123], v[136:139], v[64:67]
ds_read_b128 v[176:179], v204 offset:21760
v_mfma_f32_16x16x32_bf16 v[92:95], v[124:127], v[136:139], v[92:95]
v_mfma_f32_16x16x32_bf16 v[12:15], v[112:115], v[140:143], v[12:15]
ds_read_b128 v[180:183], v204 offset:22016
v_mfma_f32_16x16x32_bf16 v[40:43], v[116:119], v[140:143], v[40:43]
v_mfma_f32_16x16x32_bf16 v[68:71], v[120:123], v[140:143], v[68:71]
ds_read_b128 v[184:187], v204 offset:22272
v_mfma_f32_16x16x32_bf16 v[96:99], v[124:127], v[140:143], v[96:99]
v_mfma_f32_16x16x32_bf16 v[16:19], v[112:115], v[144:147], v[16:19]
ds_read_b128 v[188:191], v205 offset:22528
v_mfma_f32_16x16x32_bf16 v[44:47], v[116:119], v[144:147], v[44:47]
v_mfma_f32_16x16x32_bf16 v[72:75], v[120:123], v[144:147], v[72:75]
ds_read_b128 v[192:195], v205 offset:22784
v_mfma_f32_16x16x32_bf16 v[100:103], v[124:127], v[144:147], v[100:103]
v_mfma_f32_16x16x32_bf16 v[20:23], v[112:115], v[148:151], v[20:23]
ds_read_b128 v[196:199], v206 offset:23040
v_mfma_f32_16x16x32_bf16 v[48:51], v[116:119], v[148:151], v[48:51]
v_mfma_f32_16x16x32_bf16 v[76:79], v[120:123], v[148:151], v[76:79]
v_mfma_f32_16x16x32_bf16 v[104:107], v[124:127], v[148:151], v[104:107]
v_mfma_f32_16x16x32_bf16 v[24:27], v[112:115], v[152:155], v[24:27]
v_mfma_f32_16x16x32_bf16 v[52:55], v[116:119], v[152:155], v[52:55]
v_mfma_f32_16x16x32_bf16 v[80:83], v[120:123], v[152:155], v[80:83]
v_mfma_f32_16x16x32_bf16 v[108:111], v[124:127], v[152:155], v[108:111]
s_waitcnt lgkmcnt(0)
s_barrier
v_mfma_f32_16x16x32_bf16 v[0:3], v[156:159], v[172:175], v[0:3]
ds_read_b128 v[112:115], v202 offset:0
v_mfma_f32_16x16x32_bf16 v[28:31], v[160:163], v[172:175], v[28:31]
v_mfma_f32_16x16x32_bf16 v[56:59], v[164:167], v[172:175], v[56:59]
ds_read_b128 v[128:131], v204 offset:28672
v_mfma_f32_16x16x32_bf16 v[84:87], v[168:171], v[172:175], v[84:87]
v_mfma_f32_16x16x32_bf16 v[4:7], v[156:159], v[176:179], v[4:7]
ds_read_b128 v[116:119], v202 offset:2048
v_mfma_f32_16x16x32_bf16 v[32:35], v[160:163], v[176:179], v[32:35]
v_mfma_f32_16x16x32_bf16 v[60:63], v[164:167], v[176:179], v[60:63]
ds_read_b128 v[120:123], v202 offset:4096
v_mfma_f32_16x16x32_bf16 v[88:91], v[168:171], v[176:179], v[88:91]
v_mfma_f32_16x16x32_bf16 v[8:11], v[156:159], v[180:183], v[8:11]
ds_read_b128 v[124:127], v202 offset:6144
v_mfma_f32_16x16x32_bf16 v[36:39], v[160:163], v[180:183], v[36:39]
v_mfma_f32_16x16x32_bf16 v[64:67], v[164:167], v[180:183], v[64:67]
ds_read_b128 v[132:135], v204 offset:28928
v_mfma_f32_16x16x32_bf16 v[92:95], v[168:171], v[180:183], v[92:95]
v_mfma_f32_16x16x32_bf16 v[12:15], v[156:159], v[184:187], v[12:15]
ds_read_b128 v[136:139], v204 offset:29184
v_mfma_f32_16x16x32_bf16 v[40:43], v[160:163], v[184:187], v[40:43]
v_mfma_f32_16x16x32_bf16 v[68:71], v[164:167], v[184:187], v[68:71]
ds_read_b128 v[140:143], v204 offset:29440
v_mfma_f32_16x16x32_bf16 v[96:99], v[168:171], v[184:187], v[96:99]
v_mfma_f32_16x16x32_bf16 v[16:19], v[156:159], v[188:191], v[16:19]
ds_read_b128 v[144:147], v205 offset:29696
v_mfma_f32_16x16x32_bf16 v[44:47], v[160:163], v[188:191], v[44:47]
v_mfma_f32_16x16x32_bf16 v[72:75], v[164:167], v[188:191], v[72:75]
ds_read_b128 v[148:151], v205 offset:29952
v_mfma_f32_16x16x32_bf16 v[100:103], v[168:171], v[188:191], v[100:103]
v_mfma_f32_16x16x32_bf16 v[20:23], v[156:159], v[192:195], v[20:23]
ds_read_b128 v[152:155], v206 offset:30208
v_mfma_f32_16x16x32_bf16 v[48:51], v[160:163], v[192:195], v[48:51]
v_mfma_f32_16x16x32_bf16 v[76:79], v[164:167], v[192:195], v[76:79]
v_mfma_f32_16x16x32_bf16 v[104:107], v[168:171], v[192:195], v[104:107]
v_mfma_f32_16x16x32_bf16 v[24:27], v[156:159], v[196:199], v[24:27]
v_mfma_f32_16x16x32_bf16 v[52:55], v[160:163], v[196:199], v[52:55]
v_mfma_f32_16x16x32_bf16 v[80:83], v[164:167], v[196:199], v[80:83]
v_mfma_f32_16x16x32_bf16 v[108:111], v[168:171], v[196:199], v[108:111]
s_waitcnt lgkmcnt(0)
s_nop 0
v_mfma_f32_16x16x32_bf16 v[0:3], v[112:115], v[128:131], v[0:3]
ds_read_b128 v[156:159], v203 offset:0
v_mfma_f32_16x16x32_bf16 v[28:31], v[116:119], v[128:131], v[28:31]
v_mfma_f32_16x16x32_bf16 v[56:59], v[120:123], v[128:131], v[56:59]
ds_read_b128 v[172:175], v204 offset:35840
v_mfma_f32_16x16x32_bf16 v[84:87], v[124:127], v[128:131], v[84:87]
v_mfma_f32_16x16x32_bf16 v[4:7], v[112:115], v[132:135], v[4:7]
ds_read_b128 v[160:163], v203 offset:2048
v_mfma_f32_16x16x32_bf16 v[32:35], v[116:119], v[132:135], v[32:35]
v_mfma_f32_16x16x32_bf16 v[60:63], v[120:123], v[132:135], v[60:63]
ds_read_b128 v[164:167], v203 offset:4096
v_mfma_f32_16x16x32_bf16 v[88:91], v[124:127], v[132:135], v[88:91]
v_mfma_f32_16x16x32_bf16 v[8:11], v[112:115], v[136:139], v[8:11]
ds_read_b128 v[168:171], v203 offset:6144
v_mfma_f32_16x16x32_bf16 v[36:39], v[116:119], v[136:139], v[36:39]
v_mfma_f32_16x16x32_bf16 v[64:67], v[120:123], v[136:139], v[64:67]
ds_read_b128 v[176:179], v204 offset:36096
v_mfma_f32_16x16x32_bf16 v[92:95], v[124:127], v[136:139], v[92:95]
v_mfma_f32_16x16x32_bf16 v[12:15], v[112:115], v[140:143], v[12:15]
ds_read_b128 v[180:183], v204 offset:36352
v_mfma_f32_16x16x32_bf16 v[40:43], v[116:119], v[140:143], v[40:43]
v_mfma_f32_16x16x32_bf16 v[68:71], v[120:123], v[140:143], v[68:71]
ds_read_b128 v[184:187], v204 offset:36608
v_mfma_f32_16x16x32_bf16 v[96:99], v[124:127], v[140:143], v[96:99]
v_mfma_f32_16x16x32_bf16 v[16:19], v[112:115], v[144:147], v[16:19]
ds_read_b128 v[188:191], v205 offset:36864
v_mfma_f32_16x16x32_bf16 v[44:47], v[116:119], v[144:147], v[44:47]
v_mfma_f32_16x16x32_bf16 v[72:75], v[120:123], v[144:147], v[72:75]
ds_read_b128 v[192:195], v205 offset:37120
v_mfma_f32_16x16x32_bf16 v[100:103], v[124:127], v[144:147], v[100:103]
v_mfma_f32_16x16x32_bf16 v[20:23], v[112:115], v[148:151], v[20:23]
ds_read_b128 v[196:199], v206 offset:37376
v_mfma_f32_16x16x32_bf16 v[48:51], v[116:119], v[148:151], v[48:51]
v_mfma_f32_16x16x32_bf16 v[76:79], v[120:123], v[148:151], v[76:79]
v_mfma_f32_16x16x32_bf16 v[104:107], v[124:127], v[148:151], v[104:107]
v_mfma_f32_16x16x32_bf16 v[24:27], v[112:115], v[152:155], v[24:27]
v_mfma_f32_16x16x32_bf16 v[52:55], v[116:119], v[152:155], v[52:55]
v_mfma_f32_16x16x32_bf16 v[80:83], v[120:123], v[152:155], v[80:83]
v_mfma_f32_16x16x32_bf16 v[108:111], v[124:127], v[152:155], v[108:111]
s_waitcnt lgkmcnt(0)
s_barrier
v_mfma_f32_16x16x32_bf16 v[0:3], v[156:159], v[172:175], v[0:3]
ds_read_b128 v[112:115], v200 offset:0
v_mfma_f32_16x16x32_bf16 v[28:31], v[160:163], v[172:175], v[28:31]
v_mfma_f32_16x16x32_bf16 v[56:59], v[164:167], v[172:175], v[56:59]
ds_read_b128 v[128:131], v204 offset:0
v_mfma_f32_16x16x32_bf16 v[84:87], v[168:171], v[172:175], v[84:87]
v_mfma_f32_16x16x32_bf16 v[4:7], v[156:159], v[176:179], v[4:7]
ds_read_b128 v[116:119], v200 offset:2048
v_mfma_f32_16x16x32_bf16 v[32:35], v[160:163], v[176:179], v[32:35]
v_mfma_f32_16x16x32_bf16 v[60:63], v[164:167], v[176:179], v[60:63]
ds_read_b128 v[120:123], v200 offset:4096
v_mfma_f32_16x16x32_bf16 v[88:91], v[168:171], v[176:179], v[88:91]
v_mfma_f32_16x16x32_bf16 v[8:11], v[156:159], v[180:183], v[8:11]
ds_read_b128 v[124:127], v200 offset:6144
v_mfma_f32_16x16x32_bf16 v[36:39], v[160:163], v[180:183], v[36:39]
v_mfma_f32_16x16x32_bf16 v[64:67], v[164:167], v[180:183], v[64:67]
ds_read_b128 v[132:135], v204 offset:256
v_mfma_f32_16x16x32_bf16 v[92:95], v[168:171], v[180:183], v[92:95]
v_mfma_f32_16x16x32_bf16 v[12:15], v[156:159], v[184:187], v[12:15]
ds_read_b128 v[136:139], v204 offset:512
v_mfma_f32_16x16x32_bf16 v[40:43], v[160:163], v[184:187], v[40:43]
v_mfma_f32_16x16x32_bf16 v[68:71], v[164:167], v[184:187], v[68:71]
ds_read_b128 v[140:143], v204 offset:768
v_mfma_f32_16x16x32_bf16 v[96:99], v[168:171], v[184:187], v[96:99]
v_mfma_f32_16x16x32_bf16 v[16:19], v[156:159], v[188:191], v[16:19]
ds_read_b128 v[144:147], v205 offset:1024
v_mfma_f32_16x16x32_bf16 v[44:47], v[160:163], v[188:191], v[44:47]
v_mfma_f32_16x16x32_bf16 v[72:75], v[164:167], v[188:191], v[72:75]
ds_read_b128 v[148:151], v205 offset:1280
v_mfma_f32_16x16x32_bf16 v[100:103], v[168:171], v[188:191], v[100:103]
v_mfma_f32_16x16x32_bf16 v[20:23], v[156:159], v[192:195], v[20:23]
ds_read_b128 v[152:155], v206 offset:1536
v_mfma_f32_16x16x32_bf16 v[48:51], v[160:163], v[192:195], v[48:51]
v_mfma_f32_16x16x32_bf16 v[76:79], v[164:167], v[192:195], v[76:79]
v_mfma_f32_16x16x32_bf16 v[104:107], v[168:171], v[192:195], v[104:107]
v_mfma_f32_16x16x32_bf16 v[24:27], v[156:159], v[196:199], v[24:27]
v_mfma_f32_16x16x32_bf16 v[52:55], v[160:163], v[196:199], v[52:55]
v_mfma_f32_16x16x32_bf16 v[80:83], v[164:167], v[196:199], v[80:83]
v_mfma_f32_16x16x32_bf16 v[108:111], v[168:171], v[196:199], v[108:111]
s_waitcnt lgkmcnt(0)
s_branch L_cons
L_tail:
v_mfma_f32_16x16x32_bf16 v[0:3], v[112:115], v[128:131], v[0:3]
ds_read_b128 v[156:159], v201 offset:32768
ds_read_b128 v[172:175], v204 offset:21504
v_mfma_f32_16x16x32_bf16 v[28:31], v[116:119], v[128:131], v[28:31]
ds_read_b128 v[160:163], v201 offset:34816
ds_read_b128 v[176:179], v204 offset:21760
v_mfma_f32_16x16x32_bf16 v[4:7], v[112:115], v[132:135], v[4:7]
ds_read_b128 v[180:183], v204 offset:22016
ds_read_b128 v[184:187], v204 offset:22272
v_mfma_f32_16x16x32_bf16 v[32:35], v[116:119], v[132:135], v[32:35]
ds_read_b128 v[188:191], v205 offset:22528
ds_read_b128 v[192:195], v205 offset:22784
v_mfma_f32_16x16x32_bf16 v[8:11], v[112:115], v[136:139], v[8:11]
ds_read_b128 v[196:199], v206 offset:23040
v_mfma_f32_16x16x32_bf16 v[36:39], v[116:119], v[136:139], v[36:39]
v_mfma_f32_16x16x32_bf16 v[12:15], v[112:115], v[140:143], v[12:15]
v_mfma_f32_16x16x32_bf16 v[40:43], v[116:119], v[140:143], v[40:43]
v_mfma_f32_16x16x32_bf16 v[16:19], v[112:115], v[144:147], v[16:19]
v_mfma_f32_16x16x32_bf16 v[44:47], v[116:119], v[144:147], v[44:47]
v_mfma_f32_16x16x32_bf16 v[20:23], v[112:115], v[148:151], v[20:23]
v_mfma_f32_16x16x32_bf16 v[48:51], v[116:119], v[148:151], v[48:51]
v_mfma_f32_16x16x32_bf16 v[24:27], v[112:115], v[152:155], v[24:27]
v_mfma_f32_16x16x32_bf16 v[52:55], v[116:119], v[152:155], v[52:55]
s_waitcnt lgkmcnt(0)
s_barrier
v_mfma_f32_16x16x32_bf16 v[0:3], v[156:159], v[172:175], v[0:3]
ds_read_b128 v[112:115], v202 offset:0
ds_read_b128 v[128:131], v204 offset:28672
v_mfma_f32_16x16x32_bf16 v[28:31], v[160:163], v[172:175], v[28:31]
ds_read_b128 v[116:119], v202 offset:2048
ds_read_b128 v[132:135], v204 offset:28928
v_mfma_f32_16x16x32_bf16 v[4:7], v[156:159], v[176:179], v[4:7]
ds_read_b128 v[136:139], v204 offset:29184
ds_read_b128 v[140:143], v204 offset:29440
v_mfma_f32_16x16x32_bf16 v[32:35], v[160:163], v[176:179], v[32:35]
ds_read_b128 v[144:147], v205 offset:29696
ds_read_b128 v[148:151], v205 offset:29952
v_mfma_f32_16x16x32_bf16 v[8:11], v[156:159], v[180:183], v[8:11]
ds_read_b128 v[152:155], v206 offset:30208
v_mfma_f32_16x16x32_bf16 v[36:39], v[160:163], v[180:183], v[36:39]
v_mfma_f32_16x16x32_bf16 v[12:15], v[156:159], v[184:187], v[12:15]
v_mfma_f32_16x16x32_bf16 v[40:43], v[160:163], v[184:187], v[40:43]
v_mfma_f32_16x16x32_bf16 v[16:19], v[156:159], v[188:191], v[16:19]
v_mfma_f32_16x16x32_bf16 v[44:47], v[160:163], v[188:191], v[44:47]
v_mfma_f32_16x16x32_bf16 v[20:23], v[156:159], v[192:195], v[20:23]
v_mfma_f32_16x16x32_bf16 v[48:51], v[160:163], v[192:195], v[48:51]
v_mfma_f32_16x16x32_bf16 v[24:27], v[156:159], v[196:199], v[24:27]
v_mfma_f32_16x16x32_bf16 v[52:55], v[160:163], v[196:199], v[52:55]
s_waitcnt lgkmcnt(0)
s_nop 0
v_mfma_f32_16x16x32_bf16 v[0:3], v[112:115], v[128:131], v[0:3]
ds_read_b128 v[156:159], v203 offset:0
ds_read_b128 v[172:175], v204 offset:35840
v_mfma_f32_16x16x32_bf16 v[28:31], v[116:119], v[128:131], v[28:31]
ds_read_b128 v[160:163], v203 offset:2048
ds_read_b128 v[176:179], v204 offset:36096
v_mfma_f32_16x16x32_bf16 v[4:7], v[112:115], v[132:135], v[4:7]
ds_read_b128 v[180:183], v204 offset:36352
ds_read_b128 v[184:187], v204 offset:36608
v_mfma_f32_16x16x32_bf16 v[32:35], v[116:119], v[132:135], v[32:35]
ds_read_b128 v[188:191], v205 offset:36864
ds_read_b128 v[192:195], v205 offset:37120
v_mfma_f32_16x16x32_bf16 v[8:11], v[112:115], v[136:139], v[8:11]
ds_read_b128 v[196:199], v206 offset:37376
v_mfma_f32_16x16x32_bf16 v[36:39], v[116:119], v[136:139], v[36:39]
v_mfma_f32_16x16x32_bf16 v[12:15], v[112:115], v[140:143], v[12:15]
v_mfma_f32_16x16x32_bf16 v[40:43], v[116:119], v[140:143], v[40:43]
v_mfma_f32_16x16x32_bf16 v[16:19], v[112:115], v[144:147], v[16:19]
v_mfma_f32_16x16x32_bf16 v[44:47], v[116:119], v[144:147], v[44:47]
v_mfma_f32_16x16x32_bf16 v[20:23], v[112:115], v[148:151], v[20:23]
v_mfma_f32_16x16x32_bf16 v[48:51], v[116:119], v[148:151], v[48:51]
v_mfma_f32_16x16x32_bf16 v[24:27], v[112:115], v[152:155], v[24:27]
v_mfma_f32_16x16x32_bf16 v[52:55], v[116:119], v[152:155], v[52:55]
s_waitcnt lgkmcnt(0)
s_barrier
v_mfma_f32_16x16x32_bf16 v[0:3], v[156:159], v[172:175], v[0:3]
ds_read_b128 v[112:115], v200 offset:0
ds_read_b128 v[128:131], v204 offset:0
v_mfma_f32_16x16x32_bf16 v[28:31], v[160:163], v[172:175], v[28:31]
ds_read_b128 v[116:119], v200 offset:2048
ds_read_b128 v[132:135], v204 offset:256
v_mfma_f32_16x16x32_bf16 v[4:7], v[156:159], v[176:179], v[4:7]
ds_read_b128 v[136:139], v204 offset:512
ds_read_b128 v[140:143], v204 offset:768
v_mfma_f32_16x16x32_bf16 v[32:35], v[160:163], v[176:179], v[32:35]
ds_read_b128 v[144:147], v205 offset:1024
ds_read_b128 v[148:151], v205 offset:1280
v_mfma_f32_16x16x32_bf16 v[8:11], v[156:159], v[180:183], v[8:11]
ds_read_b128 v[152:155], v206 offset:1536
v_mfma_f32_16x16x32_bf16 v[36:39], v[160:163], v[180:183], v[36:39]
v_mfma_f32_16x16x32_bf16 v[12:15], v[156:159], v[184:187], v[12:15]
v_mfma_f32_16x16x32_bf16 v[40:43], v[160:163], v[184:187], v[40:43]
v_mfma_f32_16x16x32_bf16 v[16:19], v[156:159], v[188:191], v[16:19]
v_mfma_f32_16x16x32_bf16 v[44:47], v[160:163], v[188:191], v[44:47]
v_mfma_f32_16x16x32_bf16 v[20:23], v[156:159], v[192:195], v[20:23]
v_mfma_f32_16x16x32_bf16 v[48:51], v[160:163], v[192:195], v[48:51]
v_mfma_f32_16x16x32_bf16 v[24:27], v[156:159], v[196:199], v[24:27]
v_mfma_f32_16x16x32_bf16 v[52:55], v[160:163], v[196:199], v[52:55]
s_waitcnt lgkmcnt(0)
s_nop 0
v_mfma_f32_16x16x32_bf16 v[0:3], v[112:115], v[128:131], v[0:3]
ds_read_b128 v[156:159], v201 offset:0
ds_read_b128 v[172:175], v204 offset:7168
v_mfma_f32_16x16x32_bf16 v[28:31], v[116:119], v[128:131], v[28:31]
ds_read_b128 v[160:163], v201 offset:2048
ds_read_b128 v[176:179], v204 offset:7424
v_mfma_f32_16x16x32_bf16 v[4:7], v[112:115], v[132:135], v[4:7]
ds_read_b128 v[180:183], v204 offset:7680
ds_read_b128 v[184:187], v204 offset:7936
v_mfma_f32_16x16x32_bf16 v[32:35], v[116:119], v[132:135], v[32:35]
ds_read_b128 v[188:191], v205 offset:8192
ds_read_b128 v[192:195], v205 offset:8448
v_mfma_f32_16x16x32_bf16 v[8:11], v[112:115], v[136:139], v[8:11]
ds_read_b128 v[196:199], v206 offset:8704
v_mfma_f32_16x16x32_bf16 v[36:39], v[116:119], v[136:139], v[36:39]
v_mfma_f32_16x16x32_bf16 v[12:15], v[112:115], v[140:143], v[12:15]
v_mfma_f32_16x16x32_bf16 v[40:43], v[116:119], v[140:143], v[40:43]
v_mfma_f32_16x16x32_bf16 v[16:19], v[112:115], v[144:147], v[16:19]
v_mfma_f32_16x16x32_bf16 v[44:47], v[116:119], v[144:147], v[44:47]
v_mfma_f32_16x16x32_bf16 v[20:23], v[112:115], v[148:151], v[20:23]
v_mfma_f32_16x16x32_bf16 v[48:51], v[116:119], v[148:151], v[48:51]
v_mfma_f32_16x16x32_bf16 v[24:27], v[112:115], v[152:155], v[24:27]
v_mfma_f32_16x16x32_bf16 v[52:55], v[116:119], v[152:155], v[52:55]
s_waitcnt lgkmcnt(0)
s_nop 0
v_mfma_f32_16x16x32_bf16 v[0:3], v[156:159], v[172:175], v[0:3]
ds_read_b128 v[112:115], v200 offset:36864
ds_read_b128 v[128:131], v204 offset:14336
v_mfma_f32_16x16x32_bf16 v[4:7], v[156:159], v[176:179], v[4:7]
ds_read_b128 v[116:119], v200 offset:38912
ds_read_b128 v[132:135], v204 offset:14592
v_mfma_f32_16x16x32_bf16 v[8:11], v[156:159], v[180:183], v[8:11]
ds_read_b128 v[136:139], v204 offset:14848
ds_read_b128 v[140:143], v204 offset:15104
v_mfma_f32_16x16x32_bf16 v[12:15], v[156:159], v[184:187], v[12:15]
ds_read_b128 v[144:147], v205 offset:15360
ds_read_b128 v[148:151], v205 offset:15616
v_mfma_f32_16x16x32_bf16 v[16:19], v[156:159], v[188:191], v[16:19]
ds_read_b128 v[152:155], v206 offset:15872
v_mfma_f32_16x16x32_bf16 v[20:23], v[156:159], v[192:195], v[20:23]
v_mfma_f32_16x16x32_bf16 v[24:27], v[156:159], v[196:199], v[24:27]
v_mfma_f32_16x16x32_bf16 v[28:31], v[160:163], v[172:175], v[28:31]
v_mfma_f32_16x16x32_bf16 v[32:35], v[160:163], v[176:179], v[32:35]
v_mfma_f32_16x16x32_bf16 v[36:39], v[160:163], v[180:183], v[36:39]
v_mfma_f32_16x16x32_bf16 v[40:43], v[160:163], v[184:187], v[40:43]
v_mfma_f32_16x16x32_bf16 v[44:47], v[160:163], v[188:191], v[44:47]
v_mfma_f32_16x16x32_bf16 v[48:51], v[160:163], v[192:195], v[48:51]
v_mfma_f32_16x16x32_bf16 v[52:55], v[160:163], v[196:199], v[52:55]
s_waitcnt lgkmcnt(0)
s_nop 0
v_mfma_f32_16x16x32_bf16 v[56:59], v[112:115], v[128:131], v[56:59]
ds_read_b128 v[156:159], v201 offset:36864
ds_read_b128 v[172:175], v204 offset:21504
v_mfma_f32_16x16x32_bf16 v[84:87], v[116:119], v[128:131], v[84:87]
ds_read_b128 v[160:163], v201 offset:38912
ds_read_b128 v[176:179], v204 offset:21760
v_mfma_f32_16x16x32_bf16 v[60:63], v[112:115], v[132:135], v[60:63]
ds_read_b128 v[180:183], v204 offset:22016
ds_read_b128 v[184:187], v204 offset:22272
v_mfma_f32_16x16x32_bf16 v[88:91], v[116:119], v[132:135], v[88:91]
ds_read_b128 v[188:191], v205 offset:22528
ds_read_b128 v[192:195], v205 offset:22784
v_mfma_f32_16x16x32_bf16 v[64:67], v[112:115], v[136:139], v[64:67]
ds_read_b128 v[196:199], v206 offset:23040
v_mul_f32_e64 v0, v208, v0
v_mfma_f32_16x16x32_bf16 v[92:95], v[116:119], v[136:139], v[92:95]
v_mul_f32 v4, v209, v4
v_mul_f32 v8, v210, v8
v_mfma_f32_16x16x32_bf16 v[68:71], v[112:115], v[140:143], v[68:71]
v_mul_f32 v12, v211, v12
v_mul_f32 v16, v212, v16
v_mfma_f32_16x16x32_bf16 v[96:99], v[116:119], v[140:143], v[96:99]
v_mul_f32 v20, v213, v20
v_mul_f32 v24, v214, v24
v_mfma_f32_16x16x32_bf16 v[72:75], v[112:115], v[144:147], v[72:75]
v_cvt_pk_bf16_f32 v120, v0, v4
v_cvt_pk_bf16_f32 v121, v8, v12
v_mfma_f32_16x16x32_bf16 v[100:103], v[116:119], v[144:147], v[100:103]
v_cvt_pk_bf16_f32 v122, v16, v20
v_cvt_pk_bf16_f32 v123, v24, v24
v_mfma_f32_16x16x32_bf16 v[76:79], v[112:115], v[148:151], v[76:79]
buffer_store_dwordx2 v[120:121], v216, s[32:35], 0 offen nt
buffer_store_dword v122, v217, s[32:35], 0 offen nt
v_mfma_f32_16x16x32_bf16 v[104:107], v[116:119], v[148:151], v[104:107]
buffer_store_short v123, v218, s[32:35], 0 offen nt
v_mul_f32_e64 v1, v208, v1
v_mfma_f32_16x16x32_bf16 v[80:83], v[112:115], v[152:155], v[80:83]
v_mul_f32 v5, v209, v5
v_mul_f32 v9, v210, v9
v_mfma_f32_16x16x32_bf16 v[108:111], v[116:119], v[152:155], v[108:111]
v_mul_f32 v13, v211, v13
v_mul_f32 v17, v212, v17
s_waitcnt lgkmcnt(0)
s_nop 0
v_mfma_f32_16x16x32_bf16 v[56:59], v[156:159], v[172:175], v[56:59]
ds_read_b128 v[112:115], v202 offset:4096
ds_read_b128 v[128:131], v204 offset:28672
v_mfma_f32_16x16x32_bf16 v[84:87], v[160:163], v[172:175], v[84:87]
ds_read_b128 v[116:119], v202 offset:6144
ds_read_b128 v[132:135], v204 offset:28928
v_mfma_f32_16x16x32_bf16 v[60:63], v[156:159], v[176:179], v[60:63]
ds_read_b128 v[136:139], v204 offset:29184
ds_read_b128 v[140:143], v204 offset:29440
v_mfma_f32_16x16x32_bf16 v[88:91], v[160:163], v[176:179], v[88:91]
ds_read_b128 v[144:147], v205 offset:29696
ds_read_b128 v[148:151], v205 offset:29952
v_mfma_f32_16x16x32_bf16 v[64:67], v[156:159], v[180:183], v[64:67]
ds_read_b128 v[152:155], v206 offset:30208
v_mul_f32_e64 v21, v213, v21
v_mfma_f32_16x16x32_bf16 v[92:95], v[160:163], v[180:183], v[92:95]
v_mul_f32_e64 v25, v214, v25
v_cvt_pk_bf16_f32 v124, v1, v5
v_mfma_f32_16x16x32_bf16 v[68:71], v[156:159], v[184:187], v[68:71]
v_cvt_pk_bf16_f32 v125, v9, v13
v_cvt_pk_bf16_f32 v126, v17, v21
v_mfma_f32_16x16x32_bf16 v[96:99], v[160:163], v[184:187], v[96:99]
v_cvt_pk_bf16_f32 v127, v25, v25
s_mov_b32 s41, 7168
v_mfma_f32_16x16x32_bf16 v[72:75], v[156:159], v[188:191], v[72:75]
buffer_store_dwordx2 v[124:125], v216, s[32:35], s41 offen nt
buffer_store_dword v126, v217, s[32:35], s41 offen nt
v_mfma_f32_16x16x32_bf16 v[100:103], v[160:163], v[188:191], v[100:103]
buffer_store_short v127, v218, s[32:35], s41 offen nt
v_mul_f32_e64 v2, v208, v2
v_mfma_f32_16x16x32_bf16 v[76:79], v[156:159], v[192:195], v[76:79]
v_mul_f32 v6, v209, v6
v_mul_f32 v10, v210, v10
v_mfma_f32_16x16x32_bf16 v[104:107], v[160:163], v[192:195], v[104:107]
v_mul_f32 v14, v211, v14
v_mul_f32 v18, v212, v18
v_mfma_f32_16x16x32_bf16 v[80:83], v[156:159], v[196:199], v[80:83]
v_mul_f32 v22, v213, v22
v_mul_f32 v26, v214, v26
v_mfma_f32_16x16x32_bf16 v[108:111], v[160:163], v[196:199], v[108:111]
v_cvt_pk_bf16_f32 v164, v2, v6
v_cvt_pk_bf16_f32 v165, v10, v14
s_waitcnt lgkmcnt(0)
s_nop 0
v_mfma_f32_16x16x32_bf16 v[56:59], v[112:115], v[128:131], v[56:59]
ds_read_b128 v[156:159], v203 offset:4096
ds_read_b128 v[172:175], v204 offset:35840
v_mfma_f32_16x16x32_bf16 v[84:87], v[116:119], v[128:131], v[84:87]
ds_read_b128 v[160:163], v203 offset:6144
ds_read_b128 v[176:179], v204 offset:36096
v_mfma_f32_16x16x32_bf16 v[60:63], v[112:115], v[132:135], v[60:63]
ds_read_b128 v[180:183], v204 offset:36352
ds_read_b128 v[184:187], v204 offset:36608
v_mfma_f32_16x16x32_bf16 v[88:91], v[116:119], v[132:135], v[88:91]
ds_read_b128 v[188:191], v205 offset:36864
ds_read_b128 v[192:195], v205 offset:37120
v_mfma_f32_16x16x32_bf16 v[64:67], v[112:115], v[136:139], v[64:67]
ds_read_b128 v[196:199], v206 offset:37376
v_cvt_pk_bf16_f32 v166, v18, v22
v_mfma_f32_16x16x32_bf16 v[92:95], v[116:119], v[136:139], v[92:95]
v_cvt_pk_bf16_f32 v167, v26, v26
s_mov_b32 s41, 14336
v_mfma_f32_16x16x32_bf16 v[68:71], v[112:115], v[140:143], v[68:71]
buffer_store_dwordx2 v[164:165], v216, s[32:35], s41 offen nt
buffer_store_dword v166, v217, s[32:35], s41 offen nt
v_mfma_f32_16x16x32_bf16 v[96:99], v[116:119], v[140:143], v[96:99]
buffer_store_short v167, v218, s[32:35], s41 offen nt
v_mul_f32_e64 v3, v208, v3
v_mfma_f32_16x16x32_bf16 v[72:75], v[112:115], v[144:147], v[72:75]
v_mul_f32 v7, v209, v7
v_mul_f32 v11, v210, v11
v_mfma_f32_16x16x32_bf16 v[100:103], v[116:119], v[144:147], v[100:103]
v_mul_f32 v15, v211, v15
v_mul_f32 v19, v212, v19
v_mfma_f32_16x16x32_bf16 v[76:79], v[112:115], v[148:151], v[76:79]
v_mul_f32 v23, v213, v23
v_mul_f32 v27, v214, v27
v_mfma_f32_16x16x32_bf16 v[104:107], v[116:119], v[148:151], v[104:107]
v_cvt_pk_bf16_f32 v168, v3, v7
v_cvt_pk_bf16_f32 v169, v11, v15
v_mfma_f32_16x16x32_bf16 v[80:83], v[112:115], v[152:155], v[80:83]
v_cvt_pk_bf16_f32 v170, v19, v23
v_cvt_pk_bf16_f32 v171, v27, v27
v_mfma_f32_16x16x32_bf16 v[108:111], v[116:119], v[152:155], v[108:111]
s_mov_b32 s41, 21504
buffer_store_dwordx2 v[168:169], v216, s[32:35], s41 offen nt
s_waitcnt lgkmcnt(0)
s_nop 0
v_mfma_f32_16x16x32_bf16 v[56:59], v[156:159], v[172:175], v[56:59]
ds_read_b128 v[112:115], v200 offset:4096
ds_read_b128 v[128:131], v204 offset:0
v_mfma_f32_16x16x32_bf16 v[84:87], v[160:163], v[172:175], v[84:87]
ds_read_b128 v[116:119], v200 offset:6144
ds_read_b128 v[132:135], v204 offset:256
v_mfma_f32_16x16x32_bf16 v[60:63], v[156:159], v[176:179], v[60:63]
ds_read_b128 v[136:139], v204 offset:512
ds_read_b128 v[140:143], v204 offset:768
v_mfma_f32_16x16x32_bf16 v[88:91], v[160:163], v[176:179], v[88:91]
ds_read_b128 v[144:147], v205 offset:1024
ds_read_b128 v[148:151], v205 offset:1280
v_mfma_f32_16x16x32_bf16 v[64:67], v[156:159], v[180:183], v[64:67]
ds_read_b128 v[152:155], v206 offset:1536
buffer_store_dword v170, v217, s[32:35], s41 offen nt
v_mfma_f32_16x16x32_bf16 v[92:95], v[160:163], v[180:183], v[92:95]
buffer_store_short v171, v218, s[32:35], s41 offen nt
v_mul_f32_e64 v28, v208, v28
v_mfma_f32_16x16x32_bf16 v[68:71], v[156:159], v[184:187], v[68:71]
v_mul_f32 v32, v209, v32
v_mul_f32 v36, v210, v36
v_mfma_f32_16x16x32_bf16 v[96:99], v[160:163], v[184:187], v[96:99]
v_mul_f32 v40, v211, v40
v_mul_f32 v44, v212, v44
v_mfma_f32_16x16x32_bf16 v[72:75], v[156:159], v[188:191], v[72:75]
v_mul_f32 v48, v213, v48
v_mul_f32 v52, v214, v52
v_mfma_f32_16x16x32_bf16 v[100:103], v[160:163], v[188:191], v[100:103]
v_cvt_pk_bf16_f32 v120, v28, v32
v_cvt_pk_bf16_f32 v121, v36, v40
v_mfma_f32_16x16x32_bf16 v[76:79], v[156:159], v[192:195], v[76:79]
v_cvt_pk_bf16_f32 v122, v44, v48
v_cvt_pk_bf16_f32 v123, v52, v52
v_mfma_f32_16x16x32_bf16 v[104:107], v[160:163], v[192:195], v[104:107]
s_mov_b32 s41, 114688
buffer_store_dwordx2 v[120:121], v216, s[32:35], s41 offen nt
v_mfma_f32_16x16x32_bf16 v[80:83], v[156:159], v[196:199], v[80:83]
buffer_store_dword v122, v217, s[32:35], s41 offen nt
buffer_store_short v123, v218, s[32:35], s41 offen nt
v_mfma_f32_16x16x32_bf16 v[108:111], v[160:163], v[196:199], v[108:111]
v_mul_f32 v29, v208, v29
v_mul_f32 v33, v209, v33
s_waitcnt lgkmcnt(0)
s_nop 0
v_mfma_f32_16x16x32_bf16 v[56:59], v[112:115], v[128:131], v[56:59]
ds_read_b128 v[156:159], v201 offset:4096
ds_read_b128 v[172:175], v204 offset:7168
v_mfma_f32_16x16x32_bf16 v[84:87], v[116:119], v[128:131], v[84:87]
ds_read_b128 v[160:163], v201 offset:6144
ds_read_b128 v[176:179], v204 offset:7424
v_mfma_f32_16x16x32_bf16 v[60:63], v[112:115], v[132:135], v[60:63]
ds_read_b128 v[180:183], v204 offset:7680
ds_read_b128 v[184:187], v204 offset:7936
v_mfma_f32_16x16x32_bf16 v[88:91], v[116:119], v[132:135], v[88:91]
ds_read_b128 v[188:191], v205 offset:8192
ds_read_b128 v[192:195], v205 offset:8448
v_mfma_f32_16x16x32_bf16 v[64:67], v[112:115], v[136:139], v[64:67]
ds_read_b128 v[196:199], v206 offset:8704
v_mul_f32_e64 v37, v210, v37
v_mfma_f32_16x16x32_bf16 v[92:95], v[116:119], v[136:139], v[92:95]
v_mul_f32 v41, v211, v41
v_mul_f32 v45, v212, v45
v_mfma_f32_16x16x32_bf16 v[68:71], v[112:115], v[140:143], v[68:71]
v_mul_f32 v49, v213, v49
v_mul_f32 v53, v214, v53
v_mfma_f32_16x16x32_bf16 v[96:99], v[116:119], v[140:143], v[96:99]
v_cvt_pk_bf16_f32 v124, v29, v33
v_cvt_pk_bf16_f32 v125, v37, v41
v_mfma_f32_16x16x32_bf16 v[72:75], v[112:115], v[144:147], v[72:75]
v_cvt_pk_bf16_f32 v126, v45, v49
v_cvt_pk_bf16_f32 v127, v53, v53
v_mfma_f32_16x16x32_bf16 v[100:103], v[116:119], v[144:147], v[100:103]
s_mov_b32 s41, 121856
buffer_store_dwordx2 v[124:125], v216, s[32:35], s41 offen nt
v_mfma_f32_16x16x32_bf16 v[76:79], v[112:115], v[148:151], v[76:79]
buffer_store_dword v126, v217, s[32:35], s41 offen nt
buffer_store_short v127, v218, s[32:35], s41 offen nt
v_mfma_f32_16x16x32_bf16 v[104:107], v[116:119], v[148:151], v[104:107]
v_mul_f32 v30, v208, v30
v_mul_f32 v34, v209, v34
v_mfma_f32_16x16x32_bf16 v[80:83], v[112:115], v[152:155], v[80:83]
v_mul_f32 v38, v210, v38
v_mul_f32 v42, v211, v42
v_mfma_f32_16x16x32_bf16 v[108:111], v[116:119], v[152:155], v[108:111]
v_mul_f32 v46, v212, v46
v_mul_f32 v50, v213, v50
s_waitcnt lgkmcnt(0)
s_nop 0
v_mfma_f32_16x16x32_bf16 v[56:59], v[156:159], v[172:175], v[56:59]
v_mul_f32_e64 v54, v214, v54
v_cvt_pk_bf16_f32 v164, v30, v34
v_mfma_f32_16x16x32_bf16 v[60:63], v[156:159], v[176:179], v[60:63]
v_cvt_pk_bf16_f32 v165, v38, v42
v_cvt_pk_bf16_f32 v166, v46, v50
v_mfma_f32_16x16x32_bf16 v[64:67], v[156:159], v[180:183], v[64:67]
v_cvt_pk_bf16_f32 v167, v54, v54
s_mov_b32 s41, 129024
v_mfma_f32_16x16x32_bf16 v[68:71], v[156:159], v[184:187], v[68:71]
buffer_store_dwordx2 v[164:165], v216, s[32:35], s41 offen nt
buffer_store_dword v166, v217, s[32:35], s41 offen nt
v_mfma_f32_16x16x32_bf16 v[72:75], v[156:159], v[188:191], v[72:75]
buffer_store_short v167, v218, s[32:35], s41 offen nt
v_mul_f32_e64 v31, v208, v31
v_mfma_f32_16x16x32_bf16 v[76:79], v[156:159], v[192:195], v[76:79]
v_mul_f32 v35, v209, v35
v_mul_f32 v39, v210, v39
v_mfma_f32_16x16x32_bf16 v[80:83], v[156:159], v[196:199], v[80:83]
v_mul_f32 v43, v211, v43
v_mul_f32 v47, v212, v47
v_mfma_f32_16x16x32_bf16 v[84:87], v[160:163], v[172:175], v[84:87]
v_mul_f32 v51, v213, v51
v_mul_f32 v55, v214, v55
v_mfma_f32_16x16x32_bf16 v[88:91], v[160:163], v[176:179], v[88:91]
v_cvt_pk_bf16_f32 v168, v31, v35
v_cvt_pk_bf16_f32 v169, v39, v43
v_mfma_f32_16x16x32_bf16 v[92:95], v[160:163], v[180:183], v[92:95]
v_cvt_pk_bf16_f32 v170, v47, v51
v_cvt_pk_bf16_f32 v171, v55, v55
v_mfma_f32_16x16x32_bf16 v[96:99], v[160:163], v[184:187], v[96:99]
s_mov_b32 s41, 136192
buffer_store_dwordx2 v[168:169], v216, s[32:35], s41 offen nt
v_mfma_f32_16x16x32_bf16 v[100:103], v[160:163], v[188:191], v[100:103]
buffer_store_dword v170, v217, s[32:35], s41 offen nt
buffer_store_short v171, v218, s[32:35], s41 offen nt
v_mfma_f32_16x16x32_bf16 v[104:107], v[160:163], v[192:195], v[104:107]
v_mfma_f32_16x16x32_bf16 v[108:111], v[160:163], v[196:199], v[108:111]
s_nop 7
v_mul_f32 v56, v208, v56
v_mul_f32 v60, v209, v60
v_mul_f32 v64, v210, v64
v_mul_f32 v68, v211, v68
v_mul_f32 v72, v212, v72
v_mul_f32 v76, v213, v76
v_mul_f32 v80, v214, v80
v_cvt_pk_bf16_f32 v120, v56, v60
v_cvt_pk_bf16_f32 v121, v64, v68
v_cvt_pk_bf16_f32 v122, v72, v76
v_cvt_pk_bf16_f32 v123, v80, v80
s_mov_b32 s41, 229376
buffer_store_dwordx2 v[120:121], v216, s[32:35], s41 offen nt
buffer_store_dword v122, v217, s[32:35], s41 offen nt
buffer_store_short v123, v218, s[32:35], s41 offen nt
v_mul_f32 v57, v208, v57
v_mul_f32 v61, v209, v61
v_mul_f32 v65, v210, v65
v_mul_f32 v69, v211, v69
v_mul_f32 v73, v212, v73
v_mul_f32 v77, v213, v77
v_mul_f32_e64 v81, v214, v81
v_cvt_pk_bf16_f32 v124, v57, v61
v_cvt_pk_bf16_f32 v125, v65, v69
v_cvt_pk_bf16_f32 v126, v73, v77
v_cvt_pk_bf16_f32 v127, v81, v81
s_mov_b32 s41, 236544
buffer_store_dwordx2 v[124:125], v216, s[32:35], s41 offen nt
buffer_store_dword v126, v217, s[32:35], s41 offen nt
buffer_store_short v127, v218, s[32:35], s41 offen nt
v_mul_f32 v58, v208, v58
v_mul_f32 v62, v209, v62
v_mul_f32 v66, v210, v66
v_mul_f32 v70, v211, v70
v_mul_f32 v74, v212, v74
v_mul_f32 v78, v213, v78
v_mul_f32_e64 v82, v214, v82
v_cvt_pk_bf16_f32 v164, v58, v62
v_cvt_pk_bf16_f32 v165, v66, v70
v_cvt_pk_bf16_f32 v166, v74, v78
v_cvt_pk_bf16_f32 v167, v82, v82
s_mov_b32 s41, 243712
buffer_store_dwordx2 v[164:165], v216, s[32:35], s41 offen nt
buffer_store_dword v166, v217, s[32:35], s41 offen nt
buffer_store_short v167, v218, s[32:35], s41 offen nt
v_mul_f32 v59, v208, v59
v_mul_f32 v63, v209, v63
v_mul_f32 v67, v210, v67
v_mul_f32 v71, v211, v71
v_mul_f32 v75, v212, v75
v_mul_f32 v79, v213, v79
v_mul_f32_e64 v83, v214, v83
v_cvt_pk_bf16_f32 v168, v59, v63
v_cvt_pk_bf16_f32 v169, v67, v71
v_cvt_pk_bf16_f32 v170, v75, v79
v_cvt_pk_bf16_f32 v171, v83, v83
s_mov_b32 s41, 250880
buffer_store_dwordx2 v[168:169], v216, s[32:35], s41 offen nt
buffer_store_dword v170, v217, s[32:35], s41 offen nt
buffer_store_short v171, v218, s[32:35], s41 offen nt
v_mul_f32 v84, v208, v84
v_mul_f32 v88, v209, v88
v_mul_f32 v92, v210, v92
v_mul_f32 v96, v211, v96
v_mul_f32 v100, v212, v100
v_mul_f32 v104, v213, v104
v_mul_f32_e64 v108, v214, v108
v_cvt_pk_bf16_f32 v120, v84, v88
v_cvt_pk_bf16_f32 v121, v92, v96
v_cvt_pk_bf16_f32 v122, v100, v104
v_cvt_pk_bf16_f32 v123, v108, v108
s_mov_b32 s41, 344064
buffer_store_dwordx2 v[120:121], v216, s[32:35], s41 offen nt
buffer_store_dword v122, v217, s[32:35], s41 offen nt
buffer_store_short v123, v218, s[32:35], s41 offen nt
v_mul_f32 v85, v208, v85
v_mul_f32 v89, v209, v89
v_mul_f32 v93, v210, v93
v_mul_f32 v97, v211, v97
v_mul_f32 v101, v212, v101
v_mul_f32 v105, v213, v105
v_mul_f32_e64 v109, v214, v109
v_cvt_pk_bf16_f32 v124, v85, v89
v_cvt_pk_bf16_f32 v125, v93, v97
v_cvt_pk_bf16_f32 v126, v101, v105
v_cvt_pk_bf16_f32 v127, v109, v109
s_mov_b32 s41, 351232
buffer_store_dwordx2 v[124:125], v216, s[32:35], s41 offen nt
buffer_store_dword v126, v217, s[32:35], s41 offen nt
buffer_store_short v127, v218, s[32:35], s41 offen nt
v_mul_f32 v86, v208, v86
v_mul_f32 v90, v209, v90
v_mul_f32 v94, v210, v94
v_mul_f32 v98, v211, v98
v_mul_f32 v102, v212, v102
v_mul_f32 v106, v213, v106
v_mul_f32_e64 v110, v214, v110
v_cvt_pk_bf16_f32 v164, v86, v90
v_cvt_pk_bf16_f32 v165, v94, v98
v_cvt_pk_bf16_f32 v166, v102, v106
v_cvt_pk_bf16_f32 v167, v110, v110
s_mov_b32 s41, 358400
buffer_store_dwordx2 v[164:165], v216, s[32:35], s41 offen nt
buffer_store_dword v166, v217, s[32:35], s41 offen nt
buffer_store_short v167, v218, s[32:35], s41 offen nt
v_mul_f32 v87, v208, v87
v_mul_f32 v91, v209, v91
v_mul_f32 v95, v210, v95
v_mul_f32 v99, v211, v99
v_mul_f32 v103, v212, v103
v_mul_f32 v107, v213, v107
v_mul_f32_e64 v111, v214, v111
v_cvt_pk_bf16_f32 v168, v87, v91
v_cvt_pk_bf16_f32 v169, v95, v99
v_cvt_pk_bf16_f32 v170, v103, v107
v_cvt_pk_bf16_f32 v171, v111, v111
s_mov_b32 s41, 365568
buffer_store_dwordx2 v[168:169], v216, s[32:35], s41 offen nt
buffer_store_dword v170, v217, s[32:35], s41 offen nt
buffer_store_short v171, v218, s[32:35], s41 offen nt
s_endpgm
L_pfend:
L_fb2:
s_waitcnt lgkmcnt(0)
s_mov_b32 s48, 3
s_mov_b32 s43, 0
s_mov_b32 s63, 2
L_fbl:
s_sub_u32 s47, s48, 1
s_add_u32 s45, s47, s36
s_cmp_ge_u32 s47, 9
s_cselect_b32 s46, 0, 1
s_sub_u32 s45, s45, s46
s_and_b32 s45, s45, 7
s_xor_b32 s46, s46, 1
s_lshl_b32 s46, s46, 3
s_or_b32 s45, s45, s46
s_mul_i32 s47, s45, 917504
s_lshl_b32 s45, s45, 6
v_add_u32 v109, s45, v106
buffer_load_dwordx4 v[8:11], v140, s[24:27], s47 offen nt
buffer_load_dwordx4 v[12:15], v141, s[24:27], s47 offen nt
buffer_load_dwordx4 v[16:19], v142, s[24:27], s47 offen nt
buffer_load_dwordx4 v[20:23], v143, s[24:27], s47 offen nt
buffer_load_dwordx4 v[24:27], v144, s[24:27], s47 offen nt
buffer_load_dwordx4 v[28:31], v145, s[24:27], s47 offen nt
buffer_load_dwordx4 v[32:35], v146, s[24:27], s47 offen nt
buffer_load_dwordx4 v[36:39], v147, s[24:27], s47 offen nt
ds_read_b128 v[88:91], v109
ds_read_b128 v[92:95], v109 offset:16
s_mul_i32 s45, s63, 14336
v_add_u32 v114, s45, v102
v_add_u32 v115, s45, v103
v_add_u32 v116, s45, v104
v_add_u32 v117, s45, v105
s_cmp_lt_u32 s48, 16
s_cbranch_scc1 L_fba
s_waitcnt vmcnt(0)
s_branch L_fbc
L_fba:
s_add_u32 s45, s48, s36
s_cmp_ge_u32 s48, 9
s_cselect_b32 s46, 0, 1
s_sub_u32 s45, s45, s46
s_and_b32 s45, s45, 7
s_xor_b32 s46, s46, 1
s_lshl_b32 s46, s46, 3
s_or_b32 s45, s45, s46
s_lshl_b32 s41, s45, 7
s_lshl_b32 s45, s43, 15
s_add_u32 s60, s45, s44
s_add_u32 s61, s60, 4096
s_mov_b32 m0, s60
s_nop 0
buffer_load_dwordx4 v132, s[20:23], s41 offen offset:0  lds
buffer_load_dwordx4 v133, s[20:23], s41 offen offset:1024  lds
buffer_load_dwordx4 v134, s[20:23], s41 offen offset:2048  lds
buffer_load_dwordx4 v135, s[20:23], s41 offen offset:3072  lds
s_mov_b32 m0, s61
s_nop 0
buffer_load_dwordx4 v136, s[20:23], s41 offen offset:0  lds
buffer_load_dwordx4 v137, s[20:23], s41 offen offset:1024  lds
buffer_load_dwordx4 v138, s[20:23], s41 offen offset:2048  lds
buffer_load_dwordx4 v139, s[20:23], s41 offen offset:3072  lds
s_waitcnt vmcnt(8)
L_fbc:
s_waitcnt lgkmcnt(0)
v_cvt_f32_i32 v8, v8
v_cvt_f32_i32 v9, v9
v_cvt_f32_i32 v10, v10
v_cvt_f32_i32 v11, v11
v_sub_f32 v8, v8, v96
v_sub_f32 v9, v9, v97
v_sub_f32 v10, v10, v98
v_sub_f32 v11, v11, v99
v_mul_f32 v8, v8, v88
v_mul_f32 v9, v9, v88
v_mul_f32 v10, v10, v88
v_mul_f32 v11, v11, v88
v_cvt_f32_i32 v12, v12
v_cvt_f32_i32 v13, v13
v_cvt_f32_i32 v14, v14
v_cvt_f32_i32 v15, v15
v_sub_f32 v12, v12, v96
v_sub_f32 v13, v13, v97
v_sub_f32 v14, v14, v98
v_sub_f32 v15, v15, v99
v_mul_f32 v12, v12, v89
v_mul_f32 v13, v13, v89
v_mul_f32 v14, v14, v89
v_mul_f32 v15, v15, v89
v_cvt_pk_bf16_f32 v72, v8, v12
v_cvt_pk_bf16_f32 v76, v9, v13
v_cvt_pk_bf16_f32 v80, v10, v14
v_cvt_pk_bf16_f32 v84, v11, v15
v_cvt_f32_i32 v16, v16
v_cvt_f32_i32 v17, v17
v_cvt_f32_i32 v18, v18
v_cvt_f32_i32 v19, v19
v_sub_f32 v16, v16, v96
v_sub_f32 v17, v17, v97
v_sub_f32 v18, v18, v98
v_sub_f32 v19, v19, v99
v_mul_f32 v16, v16, v90
v_mul_f32 v17, v17, v90
v_mul_f32 v18, v18, v90
v_mul_f32 v19, v19, v90
v_cvt_f32_i32 v20, v20
v_cvt_f32_i32 v21, v21
v_cvt_f32_i32 v22, v22
v_cvt_f32_i32 v23, v23
v_sub_f32 v20, v20, v96
v_sub_f32 v21, v21, v97
v_sub_f32 v22, v22, v98
v_sub_f32 v23, v23, v99
v_mul_f32 v20, v20, v91
v_mul_f32 v21, v21, v91
v_mul_f32 v22, v22, v91
v_mul_f32 v23, v23, v91
v_cvt_pk_bf16_f32 v73, v16, v20
v_cvt_pk_bf16_f32 v77, v17, v21
v_cvt_pk_bf16_f32 v81, v18, v22
v_cvt_pk_bf16_f32 v85, v19, v23
v_cvt_f32_i32 v24, v24
v_cvt_f32_i32 v25, v25
v_cvt_f32_i32 v26, v26
v_cvt_f32_i32 v27, v27
v_sub_f32 v24, v24, v96
v_sub_f32 v25, v25, v97
v_sub_f32 v26, v26, v98
v_sub_f32 v27, v27, v99
v_mul_f32 v24, v24, v92
v_mul_f32 v25, v25, v92
v_mul_f32 v26, v26, v92
v_mul_f32 v27, v27, v92
v_cvt_f32_i32 v28, v28
v_cvt_f32_i32 v29, v29
v_cvt_f32_i32 v30, v30
v_cvt_f32_i32 v31, v31
v_sub_f32 v28, v28, v96
v_sub_f32 v29, v29, v97
v_sub_f32 v30, v30, v98
v_sub_f32 v31, v31, v99
v_mul_f32 v28, v28, v93
v_mul_f32 v29, v29, v93
v_mul_f32 v30, v30, v93
v_mul_f32 v31, v31, v93
v_cvt_pk_bf16_f32 v74, v24, v28
v_cvt_pk_bf16_f32 v78, v25, v29
v_cvt_pk_bf16_f32 v82, v26, v30
v_cvt_pk_bf16_f32 v86, v27, v31
v_cvt_f32_i32 v32, v32
v_cvt_f32_i32 v33, v33
v_cvt_f32_i32 v34, v34
v_cvt_f32_i32 v35, v35
v_sub_f32 v32, v32, v96
v_sub_f32 v33, v33, v97
v_sub_f32 v34, v34, v98
v_sub_f32 v35, v35, v99
v_mul_f32 v32, v32, v94
v_mul_f32 v33, v33, v94
v_mul_f32 v34, v34, v94
v_mul_f32 v35, v35, v94
v_cvt_f32_i32 v36, v36
v_cvt_f32_i32 v37, v37
v_cvt_f32_i32 v38, v38
v_cvt_f32_i32 v39, v39
v_sub_f32 v36, v36, v96
v_sub_f32 v37, v37, v97
v_sub_f32 v38, v38, v98
v_sub_f32 v39, v39, v99
v_mul_f32 v36, v36, v95
v_mul_f32 v37, v37, v95
v_mul_f32 v38, v38, v95
v_mul_f32 v39, v39, v95
v_cvt_pk_bf16_f32 v75, v32, v36
v_cvt_pk_bf16_f32 v79, v33, v37
v_cvt_pk_bf16_f32 v83, v34, v38
v_cvt_pk_bf16_f32 v87, v35, v39
s_mov_b64 exec, s[52:53]
ds_write_b128 v114, v[72:75]
ds_write_b128 v115, v[76:79]
ds_write_b128 v116, v[80:83]
ds_write_b128 v117, v[84:87]
s_mov_b64 exec, -1
s_mov_b32 s63, s43
s_add_u32 s43, s43, 1
s_cmp_eq_u32 s43, 3
s_cselect_b32 s43, 0, s43
s_add_u32 s48, s48, 1
s_cmp_le_u32 s48, 16
s_waitcnt lgkmcnt(0)
s_barrier
s_cbranch_scc1 L_fbl
s_waitcnt vmcnt(0)
s_branch L_fin
L_end:
s_endpgm
.section .rodata,"a"
.p2align 6
.amdhsa_kernel standalone__weight_only_int_omniquant__prompt_kernel
  .amdhsa_next_free_vgpr 256
  .amdhsa_next_free_sgpr 102
  .amdhsa_accum_offset 256
  .amdhsa_group_segment_fixed_size 0
  .amdhsa_kernarg_size 64
  .amdhsa_user_sgpr_count 2
  .amdhsa_user_sgpr_kernarg_segment_ptr 1
  .amdhsa_system_sgpr_workgroup_id_x 1
  .amdhsa_float_denorm_mode_32 3
.end_amdhsa_kernel
```
